```python
import torch

def _softmax(x, axis=-1):
    return torch.softmax(x, dim=axis)
def _gelu(x):
    return torch.nn.functional.gelu(x, approximate="tanh")
def _silu(x):
    return torch.nn.functional.silu(x)
def _sigmoid(x):
    return torch.sigmoid(x)
def _layernorm(x, axis=-1, eps=1e-5):
    m = x.mean(dim=axis, keepdim=True)
    v = x.var(dim=axis, keepdim=True, unbiased=False)
    return (x - m) / torch.sqrt(v + eps)
def _scatter_add(tgt, idx, src, axis=0):
    return tgt.clone().index_add_(axis, idx, src)
def _segment_sum(src, seg, n):
    out = torch.zeros((n,) + src.shape[1:], dtype=src.dtype)
    return out.index_add_(0, seg, src)
def _pad(x, pw):
    flat = tuple(v for pair in reversed(pw) for v in pair)
    return torch.nn.functional.pad(x, flat)

kernel_name = 'parallel_sum__linear_kernel_hedgehog__moe_arch_mod__prompt'

def setup_inputs():

    _w = (lambda a: (lambda t: t.to(torch.bfloat16) if t.is_floating_point() else t)(torch.as_tensor(a)))
    def _A_setup():
        B, S, D, H = 1, 2048, 640, 32
        Dh = D // H
        return {
            "x": _w((lambda *s: torch.randn(*s, dtype=torch.bfloat16) * 0.05)(B, S, D)),
            "wqkv": _w((lambda *s: torch.randn(*s, dtype=torch.bfloat16) * 0.4)(D, 3 * D)),
            "w_phi": _w((lambda *s: torch.randn(*s, dtype=torch.bfloat16) * 0.4)(H, Dh, Dh) * (Dh ** -0.5)),
            "wo": _w((lambda *s: torch.randn(*s, dtype=torch.bfloat16) * 0.1)(D, D)),
        }
    _A_in = _A_setup()

    def _B_setup():
        B, S, D, F, C = 1, 2048, 640, 1728, 1
        return {
            "x": _w((lambda *s: torch.randn(*s, dtype=torch.bfloat16) * 0.05)(B, S, D)),
            "w_r": _w((lambda *s: torch.randn(*s, dtype=torch.bfloat16) * 0.05)(D)),
            "w_gate": _w((lambda *s: torch.randn(*s, dtype=torch.bfloat16) * 0.05)(D, F)),
            "w_up": _w((lambda *s: torch.randn(*s, dtype=torch.bfloat16) * 0.05)(D, F)),
            "w_down": _w((lambda *s: torch.randn(*s, dtype=torch.bfloat16) * 0.05)(F, D)),
        }
    _B_in = _B_setup()

    return {
        "A_x": _A_in["x"],
        "A_wqkv": _A_in["wqkv"],
        "A_w_phi": _A_in["w_phi"],
        "A_wo": _A_in["wo"],
        "B_x": _B_in["x"],
        "B_w_r": _B_in["w_r"],
        "B_w_gate": _B_in["w_gate"],
        "B_w_up": _B_in["w_up"],
        "B_w_down": _B_in["w_down"],
    }

def reference(A_x, A_wqkv, A_w_phi, A_wo, B_x, B_w_r, B_w_gate, B_w_up, B_w_down):
    def _A_ref(x, wqkv, w_phi, wo):
        B, S, D = x.shape
        H = 32; Dh = D // H
        qkv = (lambda x, *d: x.permute(*d))((x @ wqkv).reshape(B, S, 3, H, Dh), 2, 0, 3, 1, 4)
        q, k, v = qkv[0], qkv[1], qkv[2]
        pq = torch.einsum("bhsd,hdf->bhsf", q, w_phi)
        pk = torch.einsum("bhsd,hdf->bhsf", k, w_phi)
        phi_q = torch.concatenate([_softmax(pq, axis=-1), _softmax(-pq, axis=-1)], axis=-1)
        phi_k = torch.concatenate([_softmax(pk, axis=-1), _softmax(-pk, axis=-1)], axis=-1)
        kv = torch.einsum("bhsf,bhsd->bhfd", phi_k, v)
        z  = torch.einsum("bhsf->bhf", phi_k)
        num = torch.einsum("bhqf,bhfd->bhqd", phi_q, kv)
        den = torch.einsum("bhqf,bhf->bhq", phi_q, z)[..., None] + 1e-6
        o = num / den
        return (lambda x, *d: x.permute(*d))(o, 0, 2, 1, 3).reshape(B, S, D) @ wo

    def _B_ref(x, w_r, w_gate, w_up, w_down):
        B, S, D = x.shape
        C = 1
        r = x @ w_r
        idx = torch.argsort(-r, axis=-1)[:, :C]
        idx_e = (lambda x, n, axis: torch.repeat_interleave(x, n, dim=axis))(idx.reshape(B, C, 1), D, axis=2)
        x_sel = (lambda x, i, axis: torch.take_along_dim(x, i, dim=axis))(x, idx_e, axis=1)
        g = _silu(x_sel @ w_gate)
        u = x_sel @ w_up
        y = (g * u) @ w_down
        r_sel = _sigmoid((lambda x, i, axis: torch.take_along_dim(x, i, dim=axis))(r, idx, axis=1))
        y = y * r_sel.reshape(B, C, 1)
        b_off = (torch.arange(B) * S).reshape(B, 1)
        flat_idx = (idx + b_off).reshape(B * C)
        zero = (x * 0.0).reshape(B * S, D)
        upd = _scatter_add(zero, flat_idx, y.reshape(B * C, D), axis=0)
        return x + upd.reshape(B, S, D)

    x = A_x
    xn = _layernorm(x, axis=-1)
    return x + _A_ref(xn, A_wqkv, A_w_phi, A_wo) + _B_ref(xn, B_w_r, B_w_gate, B_w_up, B_w_down)
```

```asm
; @launch grid=(256,1,1) block=(768,1,1) lds=163840
.amdgcn_target "amdgcn-amd-amdhsa--gfx950"
.text
.globl parallel_sum__linear_kernel_hedgehog__moe_arch_mod__prompt_kernel
.p2align 8
.type parallel_sum__linear_kernel_hedgehog__moe_arch_mod__prompt_kernel,@function
parallel_sum__linear_kernel_hedgehog__moe_arch_mod__prompt_kernel:
  s_cmp_ge_u32 s2, 256
  s_cbranch_scc1 L_end
  s_load_dwordx16 s[4:19], s[0:1], 0
  s_load_dwordx8 s[20:27], s[0:1], 64
  v_lshrrev_b32 v1, 6, v0
  s_nop 0
  v_readfirstlane_b32 s28, v1
  v_and_b32 v1, 63, v0
  s_and_b32 s48, s2, 7
  s_lshr_b32 s33, s2, 3
  s_bfe_u32 s31, s48, 0x10001
  s_and_b32 s32, s48, 1
  s_mov_b32 s34, 0xffff0000
  s_getpc_b64 s[46:47]
  s_and_b32 s46, s46, 0xffffff00
  s_mul_i32 s48, s33, 10
  v_min_u32 v3, 9, v1
  v_add_u32 v3, s48, v3
  v_min_u32 v3, 289, v3
  v_lshlrev_b32 v3, 7, v3
  s_cmp_lg_u32 s28, 7
  s_cbranch_scc1 L_nocpf_1
  global_load_dword v2, v3, s[46:47]
L_nocpf_1:
  s_waitcnt lgkmcnt(0)
  s_mov_b32 s56, s4
  s_mov_b32 s57, s5
  s_mov_b32 s58, 2621440
  s_mov_b32 s59, 0x20000
  s_mov_b32 s60, s6
  s_mov_b32 s61, s7
  s_mov_b32 s62, 2457600
  s_mov_b32 s63, 0x20000
  s_mov_b32 s64, s26
  s_mov_b32 s65, s27
  s_mov_b32 s66, 67108864
  s_mov_b32 s67, 0x20000
  s_load_dword s30, s[26:27], 0
  s_bitcmp1_b32 s2, 2
  s_cbranch_scc1 L_roleQ
  s_and_b32 s49, s33, 7
  s_lshl_b32 s37, s31, 3
  s_add_u32 s37, s37, s49
  s_lshr_b32 s49, s33, 3
  s_lshl_b32 s36, s32, 2
  s_add_u32 s36, s36, s49
  s_lshl_b32 s35, s37, 7
  s_and_b32 s48, s33, 3
  s_and_b32 s4, s2, 7
  s_lshl_b32 s4, s4, 2
  s_add_u32 s4, s4, s48
  s_lshr_b32 s5, s33, 2
  s_and_b32 s48, s2, 3
  s_lshr_b32 s49, s33, 2
  s_lshl_b32 s49, s49, 2
  s_add_u32 s48, s48, s49
  s_lshl_b32 s48, s48, 2
  s_and_b32 s49, s33, 3
  s_add_u32 s6, s48, s49
  s_cmp_ge_u32 s28, 8
  s_cbranch_scc1 L_help_KV
  s_bfe_u32 s48, s2, 0x10002
  s_lshl_b32 s48, s48, 1
  s_add_u32 s48, s48, s32
  s_lshl_b32 s48, s48, 5
  s_add_u32 s48, s48, s33
  s_lshl_b32 s48, s48, 3
  s_lshl_b32 s49, s31, 10
  s_add_u32 s48, s48, s49
  s_add_u32 s7, s48, s28
  s_mul_i32 s48, s7, 1280
  v_lshlrev_b32 v3, 2, v1
  buffer_load_dword v104, v3, s[56:59], s48 offen offset:0
  buffer_load_dword v105, v3, s[56:59], s48 offen offset:256
  buffer_load_dword v106, v3, s[56:59], s48 offen offset:512
  buffer_load_dword v107, v3, s[56:59], s48 offen offset:768
  buffer_load_dword v108, v3, s[56:59], s48 offen offset:1024
  s_mov_b32 s68, s14
  s_mov_b32 s69, s15
  s_mov_b32 s70, 1280
  s_mov_b32 s71, 0x20000
  buffer_load_dword v109, v3, s[68:71], 0 offen offset:0
  buffer_load_dword v110, v3, s[68:71], 0 offen offset:256
  buffer_load_dword v111, v3, s[68:71], 0 offen offset:512
  buffer_load_dword v112, v3, s[68:71], 0 offen offset:768
  buffer_load_dword v113, v3, s[68:71], 0 offen offset:1024
  s_and_b32 s48, s28, 3
  s_lshl_b32 s48, s48, 12
  s_add_u32 s48, s48, 20480
  v_and_b32 v114, 31, v1
  v_lshlrev_b32 v115, 7, v114
  v_add_u32 v115, s48, v115
  v_bfe_u32 v116, v1, 1, 3
  v_lshrrev_b32 v117, 5, v1
  v_or_b32 v118, 0, v117
  v_xor_b32 v118, v118, v116
  v_lshl_add_u32 v86, v118, 4, v115
  v_or_b32 v118, 2, v117
  v_xor_b32 v118, v118, v116
  v_lshl_add_u32 v87, v118, 4, v115
  v_or_b32 v118, 4, v117
  v_xor_b32 v118, v118, v116
  v_lshl_add_u32 v88, v118, 4, v115
  v_or_b32 v118, 6, v117
  v_xor_b32 v118, v118, v116
  v_lshl_add_u32 v89, v118, 4, v115
  v_bfe_u32 v114, v1, 4, 1
  v_and_b32 v115, 3, v1
  v_lshl_or_b32 v114, v114, 2, v115
  v_lshrrev_b32 v115, 1, v114
  v_and_b32 v116, 1, v114
  v_bfe_u32 v117, v1, 2, 2
  v_lshrrev_b32 v118, 5, v1
  v_lshl_add_u32 v117, v118, 3, v117
  v_lshlrev_b32 v118, 5, v116
  v_lshl_add_u32 v118, v115, 3, v118
  v_mul_u32_u24 v117, 320, v117
  v_add_u32 v90, v117, v118
  v_and_b32 v118, 1, v115
  v_lshlrev_b32 v118, 4, v118
  v_lshl_add_u32 v118, v116, 3, v118
  v_lshrrev_b32 v115, 1, v115
  v_mul_u32_u24 v115, 160, v115
  v_add3_u32 v118, v118, v115, v117
  v_add_u32 v91, 128, v118
  s_lshr_b32 s48, s28, 2
  s_mul_i32 s48, s48, 160
  v_add_u32 v90, s48, v90
  s_and_b32 s48, s28, 3
  s_lshl_b32 s48, s48, 5
  s_add_u32 s48, s48, s35
  s_lshl_b32 s48, s48, 4
  s_add_u32 s48, s48, 4096
  v_and_b32 v103, 31, v1
  v_lshlrev_b32 v103, 4, v103
  v_add_u32 v103, s48, v103
  v_bfe_u32 v114, v1, 4, 1
  v_and_b32 v115, 3, v1
  v_lshl_or_b32 v114, v114, 2, v115
  v_lshrrev_b32 v115, 1, v114
  v_and_b32 v116, 1, v114
  v_bfe_u32 v117, v1, 2, 2
  v_lshrrev_b32 v118, 5, v1
  s_lshr_b32 s48, s28, 2
  s_mul_i32 s48, s48, 1600
  s_add_u32 s48, s48, 151552
  v_mul_u32_u24 v119, 800, v116
  v_add_u32 v119, s48, v119
  v_lshl_add_u32 v120, v116, 2, v117
  v_mul_u32_u24 v120, 40, v120
  v_add_u32 v120, v119, v120
  v_xor_b32 v121, 1, v116
  v_lshl_add_u32 v121, v121, 4, v117
  v_mul_u32_u24 v121, 40, v121
  v_add_u32 v121, v119, v121
  v_lshl_add_u32 v94, v115, 3, v120
  v_lshl_add_u32 v96, v115, 3, v121
  v_add_u32 v95, 32, v120
  v_add_u32 v97, 32, v121
  v_mov_b32 v119, 155648
  v_cmp_eq_u32 vcc, v116, v118
  s_nop 1
  v_cndmask_b32 v94, v119, v94, vcc
  v_cndmask_b32 v96, v119, v96, vcc
  v_cmp_eq_u32 s[48:49], 0, v115
  s_nop 1
  s_and_b64 vcc, vcc, s[48:49]
  v_cndmask_b32 v95, v119, v95, vcc
  v_cndmask_b32 v97, v119, v97, vcc
  s_and_b32 s48, s28, 3
  s_lshl_b32 s48, s48, 5
  s_lshr_b32 s49, s28, 2
  s_lshl_b32 s49, s49, 1
  v_and_b32 v114, 31, v1
  v_add_u32 v114, s48, v114
  v_lshrrev_b32 v115, 5, v1
  v_add_u32 v115, s49, v115
  v_mul_u32_u24 v116, 336, v114
  v_mul_u32_u24 v117, 80, v115
  v_add_u32 v98, v116, v117
  v_mul_u32_u24 v116, 208, v114
  v_mul_u32_u24 v117, 48, v115
  v_add_u32 v116, v116, v117
  v_add_u32 v99, 43008, v116
  v_lshrrev_b32 v114, 5, v1
  v_lshlrev_b32 v114, 4, v114
  v_bfe_u32 v115, v1, 4, 1
  v_lshl_add_u32 v114, v115, 3, v114
  v_bfe_u32 v115, v1, 2, 2
  v_lshl_add_u32 v114, v115, 1, v114
  v_and_b32 v115, 3, v1
  v_lshlrev_b32 v115, 3, v115
  s_lshr_b32 s48, s28, 1
  s_and_b32 s49, s28, 1
  s_mul_i32 s50, s48, 80
  v_mul_u32_u24 v116, 336, v114
  v_add3_u32 v100, v116, v115, s50
  s_mul_i32 s50, s48, 48
  s_lshl_b32 s51, s49, 5
  s_add_u32 s50, s50, s51
  s_add_u32 s50, s50, 43008
  v_mul_u32_u24 v117, 208, v114
  v_add3_u32 v101, v117, v115, s50
  v_and_b32 v114, 15, v1
  s_lshl_b32 s50, s49, 4
  v_add_u32 v114, s50, v114
  v_mul_u32_u24 v116, 80, v114
  v_lshrrev_b32 v115, 4, v1
  v_lshl_add_u32 v116, v115, 3, v116
  s_lshl_b32 s50, s36, 1
  s_lshr_b32 s51, s48, 1
  s_add_u32 s50, s50, s51
  s_lshl_b32 s50, s50, 4
  s_add_u32 s50, s50, s37
  s_mul_i32 s50, s50, 3360
  s_and_b32 s51, s48, 1
  s_mul_i32 s51, s51, 1680
  s_add_u32 s50, s50, s51
  s_add_u32 s50, s50, 1048576
  v_add_u32 v102, s50, v116
  v_cmp_gt_u32 vcc, 21, v114
  s_nop 0
  s_mov_b64 s[72:73], vcc
  v_cmp_gt_u32 vcc, 2, v115
  s_nop 0
  s_and_b64 s[74:75], vcc, s[72:73]
  s_mov_b32 s76, s10
  s_mov_b32 s77, s11
  s_mov_b32 s78, 819200
  s_mov_b32 s79, 0x20000
  s_mul_i32 s48, s33, 200
  s_sub_u32 s49, s28, 4
  s_mul_i32 s49, s49, 50
  s_add_u32 s48, s48, s49
  v_add_u32 v92, s48, v1
  v_lshlrev_b32 v92, 7, v92
  v_mov_b32 v93, 0x7ffffff0
  s_cmp_ge_u32 s28, 4
  s_cselect_b32 s48, 50, 0
  v_cmp_gt_u32 vcc, s48, v1
  s_nop 1
  v_cndmask_b32 v92, v93, v92, vcc
  s_waitcnt lgkmcnt(0)
  s_mul_i32 s29, s30, 0x9E3779B1
  s_add_u32 s29, s29, 0x7F4A7C15
  s_waitcnt vmcnt(9)
  v_lshlrev_b32 v114, 16, v104
  v_and_b32 v115, s34, v104
  s_waitcnt vmcnt(8)
  v_lshlrev_b32 v116, 16, v105
  v_and_b32 v117, s34, v105
  s_waitcnt vmcnt(7)
  v_lshlrev_b32 v118, 16, v106
  v_and_b32 v119, s34, v106
  s_waitcnt vmcnt(6)
  v_lshlrev_b32 v120, 16, v107
  v_and_b32 v121, s34, v107
  s_waitcnt vmcnt(5)
  v_lshlrev_b32 v122, 16, v108
  v_and_b32 v123, s34, v108
  s_waitcnt vmcnt(4)
  v_lshlrev_b32 v124, 16, v109
  v_and_b32 v125, s34, v109
  s_waitcnt vmcnt(3)
  v_lshlrev_b32 v126, 16, v110
  v_and_b32 v127, s34, v110
  s_waitcnt vmcnt(2)
  v_lshlrev_b32 v128, 16, v111
  v_and_b32 v129, s34, v111
  s_waitcnt vmcnt(1)
  v_lshlrev_b32 v130, 16, v112
  v_and_b32 v131, s34, v112
  s_waitcnt vmcnt(0)
  v_lshlrev_b32 v132, 16, v113
  v_and_b32 v133, s34, v113
  v_add_f32 v134, v114, v115
  v_add_f32 v134, v134, v116
  v_add_f32 v134, v134, v117
  v_add_f32 v134, v134, v118
  v_add_f32 v134, v134, v119
  v_add_f32 v134, v134, v120
  v_add_f32 v134, v134, v121
  v_add_f32 v134, v134, v122
  v_add_f32 v134, v134, v123
  s_nop 1
  v_add_f32_dpp v134, v134, v134 row_shr:1 row_mask:0xf bank_mask:0xf bound_ctrl:0
  s_nop 1
  v_add_f32_dpp v134, v134, v134 row_shr:2 row_mask:0xf bank_mask:0xf bound_ctrl:0
  s_nop 1
  v_add_f32_dpp v134, v134, v134 row_shr:4 row_mask:0xf bank_mask:0xf bound_ctrl:0
  s_nop 1
  v_add_f32_dpp v134, v134, v134 row_shr:8 row_mask:0xf bank_mask:0xf bound_ctrl:0
  s_nop 1
  v_add_f32_dpp v134, v134, v134 row_bcast:15 row_mask:0xa bank_mask:0xf
  s_nop 1
  v_add_f32_dpp v134, v134, v134 row_bcast:31 row_mask:0xc bank_mask:0xf
  v_mul_f32 v134, 0x3acccccd, v134
  s_nop 0
  v_readlane_b32 s48, v134, 63
  s_nop 1
  v_subrev_f32 v114, s48, v114
  v_subrev_f32 v115, s48, v115
  v_subrev_f32 v116, s48, v116
  v_subrev_f32 v117, s48, v117
  v_subrev_f32 v118, s48, v118
  v_subrev_f32 v119, s48, v119
  v_subrev_f32 v120, s48, v120
  v_subrev_f32 v121, s48, v121
  v_subrev_f32 v122, s48, v122
  v_subrev_f32 v123, s48, v123
  v_mul_f32 v135, v114, v114
  v_mul_f32 v136, v114, v124
  v_fmac_f32 v135, v115, v115
  v_fmac_f32 v136, v115, v125
  v_fmac_f32 v135, v116, v116
  v_fmac_f32 v136, v116, v126
  v_fmac_f32 v135, v117, v117
  v_fmac_f32 v136, v117, v127
  v_fmac_f32 v135, v118, v118
  v_fmac_f32 v136, v118, v128
  v_fmac_f32 v135, v119, v119
  v_fmac_f32 v136, v119, v129
  v_fmac_f32 v135, v120, v120
  v_fmac_f32 v136, v120, v130
  v_fmac_f32 v135, v121, v121
  v_fmac_f32 v136, v121, v131
  v_fmac_f32 v135, v122, v122
  v_fmac_f32 v136, v122, v132
  v_fmac_f32 v135, v123, v123
  v_fmac_f32 v136, v123, v133
  s_nop 0
  v_add_f32_dpp v135, v135, v135 row_shr:1 row_mask:0xf bank_mask:0xf bound_ctrl:0
  v_add_f32_dpp v136, v136, v136 row_shr:1 row_mask:0xf bank_mask:0xf bound_ctrl:0
  s_nop 0
  v_add_f32_dpp v135, v135, v135 row_shr:2 row_mask:0xf bank_mask:0xf bound_ctrl:0
  v_add_f32_dpp v136, v136, v136 row_shr:2 row_mask:0xf bank_mask:0xf bound_ctrl:0
  s_nop 0
  v_add_f32_dpp v135, v135, v135 row_shr:4 row_mask:0xf bank_mask:0xf bound_ctrl:0
  v_add_f32_dpp v136, v136, v136 row_shr:4 row_mask:0xf bank_mask:0xf bound_ctrl:0
  s_nop 0
  v_add_f32_dpp v135, v135, v135 row_shr:8 row_mask:0xf bank_mask:0xf bound_ctrl:0
  v_add_f32_dpp v136, v136, v136 row_shr:8 row_mask:0xf bank_mask:0xf bound_ctrl:0
  s_nop 0
  v_add_f32_dpp v135, v135, v135 row_bcast:15 row_mask:0xa bank_mask:0xf
  v_add_f32_dpp v136, v136, v136 row_bcast:15 row_mask:0xa bank_mask:0xf
  s_nop 0
  v_add_f32_dpp v135, v135, v135 row_bcast:31 row_mask:0xc bank_mask:0xf
  v_add_f32_dpp v136, v136, v136 row_bcast:31 row_mask:0xc bank_mask:0xf
  v_mul_f32 v135, 0x3acccccd, v135
  v_add_f32 v135, 0x3727c5ac, v135
  v_rsq_f32 v135, v135
  s_nop 0
  v_mul_f32 v136, v136, v135
  v_readlane_b32 s49, v135, 63
  v_readlane_b32 s50, v136, 63
  v_mov_b32 v140, s48
  v_mov_b32 v141, s29
  v_mov_b32 v142, s49
  v_mov_b32 v143, s29
  s_lshl_b32 s51, s7, 4
  s_add_u32 s51, s51, 4096
  s_ashr_i32 s52, s50, 31
  s_or_b32 s52, s52, 0x80000000
  s_xor_b32 s52, s52, s50
  s_and_b32 s52, s52, 0xfffff800
  s_sub_u32 s53, 2047, s7
  s_or_b32 s52, s52, s53
  s_lshl_b32 s53, s28, 2
  s_add_u32 s53, s53, 156672
  v_mov_b32 v134, s52
  v_mov_b32 v135, s53
  v_mov_b32 v137, 0
  s_mov_b64 s[54:55], exec
  s_mov_b64 exec, 1
  buffer_store_dwordx4 v[140:143], v137, s[64:67], s51 offen sc1
  ds_write_b32 v135, v134
  s_mov_b64 exec, s[54:55]
  s_waitcnt lgkmcnt(0)
  v_mov_b32 v4, 0
  v_mov_b32 v5, 0
  v_mov_b32 v6, 0
  v_mov_b32 v7, 0
  v_mov_b32 v8, 0
  v_mov_b32 v9, 0
  v_mov_b32 v10, 0
  v_mov_b32 v11, 0
  v_mov_b32 v12, 0
  v_mov_b32 v13, 0
  v_mov_b32 v14, 0
  v_mov_b32 v15, 0
  v_mov_b32 v16, 0
  v_mov_b32 v17, 0
  v_mov_b32 v18, 0
  v_mov_b32 v19, 0
  v_mov_b32 v20, 0
  v_mov_b32 v21, 0
  v_mov_b32 v22, 0
  v_mov_b32 v23, 0
  v_mov_b32 v24, 0
  v_mov_b32 v25, 0
  v_mov_b32 v26, 0
  v_mov_b32 v27, 0
  v_mov_b32 v28, 0
  v_mov_b32 v29, 0
  v_mov_b32 v30, 0
  v_mov_b32 v31, 0
  v_mov_b32 v32, 0
  v_mov_b32 v33, 0
  v_mov_b32 v34, 0
  v_mov_b32 v35, 0
  v_mov_b32 v36, 0
  v_mov_b32 v37, 0
  v_mov_b32 v38, 0
  v_mov_b32 v39, 0
  v_mov_b32 v40, 0
  v_mov_b32 v41, 0
  v_mov_b32 v42, 0
  v_mov_b32 v43, 0
  v_mov_b32 v44, 0
  v_mov_b32 v45, 0
  v_mov_b32 v46, 0
  v_mov_b32 v47, 0
  v_mov_b32 v48, 0
  v_mov_b32 v49, 0
  v_mov_b32 v50, 0
  v_mov_b32 v51, 0
  v_mov_b32 v80, 0
  v_mov_b32 v81, 0
  v_mov_b32 v82, 0
  v_mov_b32 v83, 0
  v_mov_b32 v84, 0
  v_mov_b32 v85, 0
  s_waitcnt lgkmcnt(0)
  s_cmp_ge_u32 s28, 4
  s_cbranch_scc1 L_c1_KV
  s_lshr_b32 s12, s28, 1
  s_and_b32 s12, s12, 2
  s_add_u32 s12, s12, s28
  s_and_b32 s12, s12, 3
  s_mov_b32 s38, 0
  s_mov_b32 s41, 0
  s_barrier
  ds_read_b128 v[104:107], v86
  ds_read_b64_tr_b16 v[108:109], v90 offset:0
  ds_read_b64_tr_b16 v[110:111], v90 offset:1280
  ds_read_b64_tr_b16 v[112:113], v90 offset:64
  ds_read_b64_tr_b16 v[114:115], v90 offset:1344
  ds_read_b64_tr_b16 v[116:117], v91 offset:0
  ds_read_b64_tr_b16 v[118:119], v91 offset:1280
  ds_read_b128 v[120:123], v87
  ds_read_b64_tr_b16 v[124:125], v90 offset:5120
  ds_read_b64_tr_b16 v[126:127], v90 offset:6400
  ds_read_b64_tr_b16 v[128:129], v90 offset:5184
  ds_read_b64_tr_b16 v[130:131], v90 offset:6464
  ds_read_b64_tr_b16 v[132:133], v91 offset:5120
  ds_read_b64_tr_b16 v[134:135], v91 offset:6400
L_cloop_KV0:
  s_waitcnt lgkmcnt(7)
  s_cmp_lg_u32 s12, 0
  s_cbranch_scc1 L_plain_2
  s_cmp_eq_u32 s38, 1
  s_cbranch_scc1 L_cst1_5
  s_cmp_eq_u32 s38, 2
  s_cbranch_scc1 L_cst2_6
L_cst0_4:
  v_mfma_f32_32x32x16_bf16 v[4:19], v[108:111], v[104:107], v[4:19]
  ds_read_b128 v[136:139], v88
  ds_read_b64_tr_b16 v[140:141], v90 offset:10240
  ds_read_b64_tr_b16 v[142:143], v90 offset:11520
  v_and_b32 v52, s34, v108
  v_lshlrev_b32 v53, 16, v108
  v_and_b32 v54, s34, v109
  v_lshlrev_b32 v55, 16, v109
  v_add_f32 v80, v80, v52
  v_add_f32 v81, v81, v53
  v_mfma_f32_32x32x16_bf16 v[20:35], v[112:115], v[104:107], v[20:35]
  ds_read_b64_tr_b16 v[144:145], v90 offset:10304
  ds_read_b64_tr_b16 v[146:147], v90 offset:11584
  ds_read_b64_tr_b16 v[148:149], v91 offset:10240
  v_add_f32 v80, v80, v54
  v_add_f32 v81, v81, v55
  v_and_b32 v52, s34, v110
  v_lshlrev_b32 v53, 16, v110
  v_and_b32 v54, s34, v111
  v_lshlrev_b32 v55, 16, v111
  v_mfma_f32_32x32x16_bf16 v[36:51], v[116:119], v[104:107], v[36:51]
  ds_read_b64_tr_b16 v[150:151], v91 offset:11520
  v_add_f32 v80, v80, v52
  v_add_f32 v81, v81, v53
  v_add_f32 v80, v80, v54
  v_add_f32 v81, v81, v55
  s_branch L_stepdone_3
L_cst1_5:
  v_mfma_f32_32x32x16_bf16 v[4:19], v[108:111], v[104:107], v[4:19]
  ds_read_b128 v[136:139], v88
  ds_read_b64_tr_b16 v[140:141], v90 offset:10240
  ds_read_b64_tr_b16 v[142:143], v90 offset:11520
  v_and_b32 v52, s34, v112
  v_lshlrev_b32 v53, 16, v112
  v_and_b32 v54, s34, v113
  v_lshlrev_b32 v55, 16, v113
  v_add_f32 v82, v82, v52
  v_add_f32 v83, v83, v53
  v_mfma_f32_32x32x16_bf16 v[20:35], v[112:115], v[104:107], v[20:35]
  ds_read_b64_tr_b16 v[144:145], v90 offset:10304
  ds_read_b64_tr_b16 v[146:147], v90 offset:11584
  ds_read_b64_tr_b16 v[148:149], v91 offset:10240
  v_add_f32 v82, v82, v54
  v_add_f32 v83, v83, v55
  v_and_b32 v52, s34, v114
  v_lshlrev_b32 v53, 16, v114
  v_and_b32 v54, s34, v115
  v_lshlrev_b32 v55, 16, v115
  v_mfma_f32_32x32x16_bf16 v[36:51], v[116:119], v[104:107], v[36:51]
  ds_read_b64_tr_b16 v[150:151], v91 offset:11520
  v_add_f32 v82, v82, v52
  v_add_f32 v83, v83, v53
  v_add_f32 v82, v82, v54
  v_add_f32 v83, v83, v55
  s_branch L_stepdone_3
L_cst2_6:
  v_mfma_f32_32x32x16_bf16 v[4:19], v[108:111], v[104:107], v[4:19]
  ds_read_b128 v[136:139], v88
  ds_read_b64_tr_b16 v[140:141], v90 offset:10240
  ds_read_b64_tr_b16 v[142:143], v90 offset:11520
  v_and_b32 v52, s34, v116
  v_lshlrev_b32 v53, 16, v116
  v_and_b32 v54, s34, v117
  v_lshlrev_b32 v55, 16, v117
  v_add_f32 v84, v84, v52
  v_add_f32 v85, v85, v53
  v_mfma_f32_32x32x16_bf16 v[20:35], v[112:115], v[104:107], v[20:35]
  ds_read_b64_tr_b16 v[144:145], v90 offset:10304
  ds_read_b64_tr_b16 v[146:147], v90 offset:11584
  ds_read_b64_tr_b16 v[148:149], v91 offset:10240
  v_add_f32 v84, v84, v54
  v_add_f32 v85, v85, v55
  v_and_b32 v52, s34, v118
  v_lshlrev_b32 v53, 16, v118
  v_and_b32 v54, s34, v119
  v_lshlrev_b32 v55, 16, v119
  v_mfma_f32_32x32x16_bf16 v[36:51], v[116:119], v[104:107], v[36:51]
  ds_read_b64_tr_b16 v[150:151], v91 offset:11520
  v_add_f32 v84, v84, v52
  v_add_f32 v85, v85, v53
  v_add_f32 v84, v84, v54
  v_add_f32 v85, v85, v55
  s_branch L_stepdone_3
L_plain_2:
  v_mfma_f32_32x32x16_bf16 v[4:19], v[108:111], v[104:107], v[4:19]
  ds_read_b128 v[136:139], v88
  ds_read_b64_tr_b16 v[140:141], v90 offset:10240
  ds_read_b64_tr_b16 v[142:143], v90 offset:11520
  v_mfma_f32_32x32x16_bf16 v[20:35], v[112:115], v[104:107], v[20:35]
  ds_read_b64_tr_b16 v[144:145], v90 offset:10304
  ds_read_b64_tr_b16 v[146:147], v90 offset:11584
  ds_read_b64_tr_b16 v[148:149], v91 offset:10240
  v_mfma_f32_32x32x16_bf16 v[36:51], v[116:119], v[104:107], v[36:51]
  ds_read_b64_tr_b16 v[150:151], v91 offset:11520
L_stepdone_3:
  s_waitcnt lgkmcnt(7)
  s_cmp_lg_u32 s12, 1
  s_cbranch_scc1 L_plain_7
  s_cmp_eq_u32 s38, 1
  s_cbranch_scc1 L_cst1_10
  s_cmp_eq_u32 s38, 2
  s_cbranch_scc1 L_cst2_11
L_cst0_9:
  v_mfma_f32_32x32x16_bf16 v[4:19], v[124:127], v[120:123], v[4:19]
  ds_read_b128 v[152:155], v89
  ds_read_b64_tr_b16 v[156:157], v90 offset:15360
  ds_read_b64_tr_b16 v[158:159], v90 offset:16640
  v_and_b32 v52, s34, v124
  v_lshlrev_b32 v53, 16, v124
  v_and_b32 v54, s34, v125
  v_lshlrev_b32 v55, 16, v125
  v_add_f32 v80, v80, v52
  v_add_f32 v81, v81, v53
  v_mfma_f32_32x32x16_bf16 v[20:35], v[128:131], v[120:123], v[20:35]
  ds_read_b64_tr_b16 v[160:161], v90 offset:15424
  ds_read_b64_tr_b16 v[162:163], v90 offset:16704
  ds_read_b64_tr_b16 v[164:165], v91 offset:15360
  v_add_f32 v80, v80, v54
  v_add_f32 v81, v81, v55
  v_and_b32 v52, s34, v126
  v_lshlrev_b32 v53, 16, v126
  v_and_b32 v54, s34, v127
  v_lshlrev_b32 v55, 16, v127
  v_mfma_f32_32x32x16_bf16 v[36:51], v[132:135], v[120:123], v[36:51]
  ds_read_b64_tr_b16 v[166:167], v91 offset:16640
  v_add_f32 v80, v80, v52
  v_add_f32 v81, v81, v53
  v_add_f32 v80, v80, v54
  v_add_f32 v81, v81, v55
  s_branch L_stepdone_8
L_cst1_10:
  v_mfma_f32_32x32x16_bf16 v[4:19], v[124:127], v[120:123], v[4:19]
  ds_read_b128 v[152:155], v89
  ds_read_b64_tr_b16 v[156:157], v90 offset:15360
  ds_read_b64_tr_b16 v[158:159], v90 offset:16640
  v_and_b32 v52, s34, v128
  v_lshlrev_b32 v53, 16, v128
  v_and_b32 v54, s34, v129
  v_lshlrev_b32 v55, 16, v129
  v_add_f32 v82, v82, v52
  v_add_f32 v83, v83, v53
  v_mfma_f32_32x32x16_bf16 v[20:35], v[128:131], v[120:123], v[20:35]
  ds_read_b64_tr_b16 v[160:161], v90 offset:15424
  ds_read_b64_tr_b16 v[162:163], v90 offset:16704
  ds_read_b64_tr_b16 v[164:165], v91 offset:15360
  v_add_f32 v82, v82, v54
  v_add_f32 v83, v83, v55
  v_and_b32 v52, s34, v130
  v_lshlrev_b32 v53, 16, v130
  v_and_b32 v54, s34, v131
  v_lshlrev_b32 v55, 16, v131
  v_mfma_f32_32x32x16_bf16 v[36:51], v[132:135], v[120:123], v[36:51]
  ds_read_b64_tr_b16 v[166:167], v91 offset:16640
  v_add_f32 v82, v82, v52
  v_add_f32 v83, v83, v53
  v_add_f32 v82, v82, v54
  v_add_f32 v83, v83, v55
  s_branch L_stepdone_8
L_cst2_11:
  v_mfma_f32_32x32x16_bf16 v[4:19], v[124:127], v[120:123], v[4:19]
  ds_read_b128 v[152:155], v89
  ds_read_b64_tr_b16 v[156:157], v90 offset:15360
  ds_read_b64_tr_b16 v[158:159], v90 offset:16640
  v_and_b32 v52, s34, v132
  v_lshlrev_b32 v53, 16, v132
  v_and_b32 v54, s34, v133
  v_lshlrev_b32 v55, 16, v133
  v_add_f32 v84, v84, v52
  v_add_f32 v85, v85, v53
  v_mfma_f32_32x32x16_bf16 v[20:35], v[128:131], v[120:123], v[20:35]
  ds_read_b64_tr_b16 v[160:161], v90 offset:15424
  ds_read_b64_tr_b16 v[162:163], v90 offset:16704
  ds_read_b64_tr_b16 v[164:165], v91 offset:15360
  v_add_f32 v84, v84, v54
  v_add_f32 v85, v85, v55
  v_and_b32 v52, s34, v134
  v_lshlrev_b32 v53, 16, v134
  v_and_b32 v54, s34, v135
  v_lshlrev_b32 v55, 16, v135
  v_mfma_f32_32x32x16_bf16 v[36:51], v[132:135], v[120:123], v[36:51]
  ds_read_b64_tr_b16 v[166:167], v91 offset:16640
  v_add_f32 v84, v84, v52
  v_add_f32 v85, v85, v53
  v_add_f32 v84, v84, v54
  v_add_f32 v85, v85, v55
  s_branch L_stepdone_8
L_plain_7:
  v_mfma_f32_32x32x16_bf16 v[4:19], v[124:127], v[120:123], v[4:19]
  ds_read_b128 v[152:155], v89
  ds_read_b64_tr_b16 v[156:157], v90 offset:15360
  ds_read_b64_tr_b16 v[158:159], v90 offset:16640
  v_mfma_f32_32x32x16_bf16 v[20:35], v[128:131], v[120:123], v[20:35]
  ds_read_b64_tr_b16 v[160:161], v90 offset:15424
  ds_read_b64_tr_b16 v[162:163], v90 offset:16704
  ds_read_b64_tr_b16 v[164:165], v91 offset:15360
  v_mfma_f32_32x32x16_bf16 v[36:51], v[132:135], v[120:123], v[36:51]
  ds_read_b64_tr_b16 v[166:167], v91 offset:16640
L_stepdone_8:
  s_cmp_eq_u32 s38, 9
  s_cbranch_scc1 L_last_12
  s_cmp_lg_u32 s38, 6
  s_cbranch_scc1 L_nostat_13
  buffer_load_dwordx4 v[76:79], v103, s[64:67], 0 offen sc1
L_nostat_13:
  s_add_u32 s41, s41, 36864
  s_cmp_eq_u32 s41, 147456
  s_cselect_b32 s41, 0, s41
  s_mov_b32 s42, 36864
  s_cselect_b32 s42, 4294856704, s42
  v_add_u32 v86, s42, v86
  v_add_u32 v87, s42, v87
  v_add_u32 v88, s42, v88
  v_add_u32 v89, s42, v89
  v_add_u32 v90, s42, v90
  v_add_u32 v91, s42, v91
  s_barrier
  s_waitcnt lgkmcnt(7)
  s_cmp_lg_u32 s12, 2
  s_cbranch_scc1 L_plain_14
  s_cmp_eq_u32 s38, 1
  s_cbranch_scc1 L_cst1_17
  s_cmp_eq_u32 s38, 2
  s_cbranch_scc1 L_cst2_18
L_cst0_16:
  v_mfma_f32_32x32x16_bf16 v[4:19], v[140:143], v[136:139], v[4:19]
  ds_read_b128 v[104:107], v86
  ds_read_b64_tr_b16 v[108:109], v90 offset:0
  ds_read_b64_tr_b16 v[110:111], v90 offset:1280
  v_and_b32 v52, s34, v140
  v_lshlrev_b32 v53, 16, v140
  v_and_b32 v54, s34, v141
  v_lshlrev_b32 v55, 16, v141
  v_add_f32 v80, v80, v52
  v_add_f32 v81, v81, v53
  v_mfma_f32_32x32x16_bf16 v[20:35], v[144:147], v[136:139], v[20:35]
  ds_read_b64_tr_b16 v[112:113], v90 offset:64
  ds_read_b64_tr_b16 v[114:115], v90 offset:1344
  ds_read_b64_tr_b16 v[116:117], v91 offset:0
  v_add_f32 v80, v80, v54
  v_add_f32 v81, v81, v55
  v_and_b32 v52, s34, v142
  v_lshlrev_b32 v53, 16, v142
  v_and_b32 v54, s34, v143
  v_lshlrev_b32 v55, 16, v143
  v_mfma_f32_32x32x16_bf16 v[36:51], v[148:151], v[136:139], v[36:51]
  ds_read_b64_tr_b16 v[118:119], v91 offset:1280
  v_add_f32 v80, v80, v52
  v_add_f32 v81, v81, v53
  v_add_f32 v80, v80, v54
  v_add_f32 v81, v81, v55
  s_branch L_stepdone_15
L_cst1_17:
  v_mfma_f32_32x32x16_bf16 v[4:19], v[140:143], v[136:139], v[4:19]
  ds_read_b128 v[104:107], v86
  ds_read_b64_tr_b16 v[108:109], v90 offset:0
  ds_read_b64_tr_b16 v[110:111], v90 offset:1280
  v_and_b32 v52, s34, v144
  v_lshlrev_b32 v53, 16, v144
  v_and_b32 v54, s34, v145
  v_lshlrev_b32 v55, 16, v145
  v_add_f32 v82, v82, v52
  v_add_f32 v83, v83, v53
  v_mfma_f32_32x32x16_bf16 v[20:35], v[144:147], v[136:139], v[20:35]
  ds_read_b64_tr_b16 v[112:113], v90 offset:64
  ds_read_b64_tr_b16 v[114:115], v90 offset:1344
  ds_read_b64_tr_b16 v[116:117], v91 offset:0
  v_add_f32 v82, v82, v54
  v_add_f32 v83, v83, v55
  v_and_b32 v52, s34, v146
  v_lshlrev_b32 v53, 16, v146
  v_and_b32 v54, s34, v147
  v_lshlrev_b32 v55, 16, v147
  v_mfma_f32_32x32x16_bf16 v[36:51], v[148:151], v[136:139], v[36:51]
  ds_read_b64_tr_b16 v[118:119], v91 offset:1280
  v_add_f32 v82, v82, v52
  v_add_f32 v83, v83, v53
  v_add_f32 v82, v82, v54
  v_add_f32 v83, v83, v55
  s_branch L_stepdone_15
L_cst2_18:
  v_mfma_f32_32x32x16_bf16 v[4:19], v[140:143], v[136:139], v[4:19]
  ds_read_b128 v[104:107], v86
  ds_read_b64_tr_b16 v[108:109], v90 offset:0
  ds_read_b64_tr_b16 v[110:111], v90 offset:1280
  v_and_b32 v52, s34, v148
  v_lshlrev_b32 v53, 16, v148
  v_and_b32 v54, s34, v149
  v_lshlrev_b32 v55, 16, v149
  v_add_f32 v84, v84, v52
  v_add_f32 v85, v85, v53
  v_mfma_f32_32x32x16_bf16 v[20:35], v[144:147], v[136:139], v[20:35]
  ds_read_b64_tr_b16 v[112:113], v90 offset:64
  ds_read_b64_tr_b16 v[114:115], v90 offset:1344
  ds_read_b64_tr_b16 v[116:117], v91 offset:0
  v_add_f32 v84, v84, v54
  v_add_f32 v85, v85, v55
  v_and_b32 v52, s34, v150
  v_lshlrev_b32 v53, 16, v150
  v_and_b32 v54, s34, v151
  v_lshlrev_b32 v55, 16, v151
  v_mfma_f32_32x32x16_bf16 v[36:51], v[148:151], v[136:139], v[36:51]
  ds_read_b64_tr_b16 v[118:119], v91 offset:1280
  v_add_f32 v84, v84, v52
  v_add_f32 v85, v85, v53
  v_add_f32 v84, v84, v54
  v_add_f32 v85, v85, v55
  s_branch L_stepdone_15
L_plain_14:
  v_mfma_f32_32x32x16_bf16 v[4:19], v[140:143], v[136:139], v[4:19]
  ds_read_b128 v[104:107], v86
  ds_read_b64_tr_b16 v[108:109], v90 offset:0
  ds_read_b64_tr_b16 v[110:111], v90 offset:1280
  v_mfma_f32_32x32x16_bf16 v[20:35], v[144:147], v[136:139], v[20:35]
  ds_read_b64_tr_b16 v[112:113], v90 offset:64
  ds_read_b64_tr_b16 v[114:115], v90 offset:1344
  ds_read_b64_tr_b16 v[116:117], v91 offset:0
  v_mfma_f32_32x32x16_bf16 v[36:51], v[148:151], v[136:139], v[36:51]
  ds_read_b64_tr_b16 v[118:119], v91 offset:1280
L_stepdone_15:
  s_waitcnt lgkmcnt(7)
  s_cmp_lg_u32 s12, 3
  s_cbranch_scc1 L_plain_19
  s_cmp_eq_u32 s38, 1
  s_cbranch_scc1 L_cst1_22
  s_cmp_eq_u32 s38, 2
  s_cbranch_scc1 L_cst2_23
L_cst0_21:
  v_mfma_f32_32x32x16_bf16 v[4:19], v[156:159], v[152:155], v[4:19]
  ds_read_b128 v[120:123], v87
  ds_read_b64_tr_b16 v[124:125], v90 offset:5120
  ds_read_b64_tr_b16 v[126:127], v90 offset:6400
  v_and_b32 v52, s34, v156
  v_lshlrev_b32 v53, 16, v156
  v_and_b32 v54, s34, v157
  v_lshlrev_b32 v55, 16, v157
  v_add_f32 v80, v80, v52
  v_add_f32 v81, v81, v53
  v_mfma_f32_32x32x16_bf16 v[20:35], v[160:163], v[152:155], v[20:35]
  ds_read_b64_tr_b16 v[128:129], v90 offset:5184
  ds_read_b64_tr_b16 v[130:131], v90 offset:6464
  ds_read_b64_tr_b16 v[132:133], v91 offset:5120
  v_add_f32 v80, v80, v54
  v_add_f32 v81, v81, v55
  v_and_b32 v52, s34, v158
  v_lshlrev_b32 v53, 16, v158
  v_and_b32 v54, s34, v159
  v_lshlrev_b32 v55, 16, v159
  v_mfma_f32_32x32x16_bf16 v[36:51], v[164:167], v[152:155], v[36:51]
  ds_read_b64_tr_b16 v[134:135], v91 offset:6400
  v_add_f32 v80, v80, v52
  v_add_f32 v81, v81, v53
  v_add_f32 v80, v80, v54
  v_add_f32 v81, v81, v55
  s_branch L_stepdone_20
L_cst1_22:
  v_mfma_f32_32x32x16_bf16 v[4:19], v[156:159], v[152:155], v[4:19]
  ds_read_b128 v[120:123], v87
  ds_read_b64_tr_b16 v[124:125], v90 offset:5120
  ds_read_b64_tr_b16 v[126:127], v90 offset:6400
  v_and_b32 v52, s34, v160
  v_lshlrev_b32 v53, 16, v160
  v_and_b32 v54, s34, v161
  v_lshlrev_b32 v55, 16, v161
  v_add_f32 v82, v82, v52
  v_add_f32 v83, v83, v53
  v_mfma_f32_32x32x16_bf16 v[20:35], v[160:163], v[152:155], v[20:35]
  ds_read_b64_tr_b16 v[128:129], v90 offset:5184
  ds_read_b64_tr_b16 v[130:131], v90 offset:6464
  ds_read_b64_tr_b16 v[132:133], v91 offset:5120
  v_add_f32 v82, v82, v54
  v_add_f32 v83, v83, v55
  v_and_b32 v52, s34, v162
  v_lshlrev_b32 v53, 16, v162
  v_and_b32 v54, s34, v163
  v_lshlrev_b32 v55, 16, v163
  v_mfma_f32_32x32x16_bf16 v[36:51], v[164:167], v[152:155], v[36:51]
  ds_read_b64_tr_b16 v[134:135], v91 offset:6400
  v_add_f32 v82, v82, v52
  v_add_f32 v83, v83, v53
  v_add_f32 v82, v82, v54
  v_add_f32 v83, v83, v55
  s_branch L_stepdone_20
L_cst2_23:
  v_mfma_f32_32x32x16_bf16 v[4:19], v[156:159], v[152:155], v[4:19]
  ds_read_b128 v[120:123], v87
  ds_read_b64_tr_b16 v[124:125], v90 offset:5120
  ds_read_b64_tr_b16 v[126:127], v90 offset:6400
  v_and_b32 v52, s34, v164
  v_lshlrev_b32 v53, 16, v164
  v_and_b32 v54, s34, v165
  v_lshlrev_b32 v55, 16, v165
  v_add_f32 v84, v84, v52
  v_add_f32 v85, v85, v53
  v_mfma_f32_32x32x16_bf16 v[20:35], v[160:163], v[152:155], v[20:35]
  ds_read_b64_tr_b16 v[128:129], v90 offset:5184
  ds_read_b64_tr_b16 v[130:131], v90 offset:6464
  ds_read_b64_tr_b16 v[132:133], v91 offset:5120
  v_add_f32 v84, v84, v54
  v_add_f32 v85, v85, v55
  v_and_b32 v52, s34, v166
  v_lshlrev_b32 v53, 16, v166
  v_and_b32 v54, s34, v167
  v_lshlrev_b32 v55, 16, v167
  v_mfma_f32_32x32x16_bf16 v[36:51], v[164:167], v[152:155], v[36:51]
  ds_read_b64_tr_b16 v[134:135], v91 offset:6400
  v_add_f32 v84, v84, v52
  v_add_f32 v85, v85, v53
  v_add_f32 v84, v84, v54
  v_add_f32 v85, v85, v55
  s_branch L_stepdone_20
L_plain_19:
  v_mfma_f32_32x32x16_bf16 v[4:19], v[156:159], v[152:155], v[4:19]
  ds_read_b128 v[120:123], v87
  ds_read_b64_tr_b16 v[124:125], v90 offset:5120
  ds_read_b64_tr_b16 v[126:127], v90 offset:6400
  v_mfma_f32_32x32x16_bf16 v[20:35], v[160:163], v[152:155], v[20:35]
  ds_read_b64_tr_b16 v[128:129], v90 offset:5184
  ds_read_b64_tr_b16 v[130:131], v90 offset:6464
  ds_read_b64_tr_b16 v[132:133], v91 offset:5120
  v_mfma_f32_32x32x16_bf16 v[36:51], v[164:167], v[152:155], v[36:51]
  ds_read_b64_tr_b16 v[134:135], v91 offset:6400
L_stepdone_20:
  s_cmp_lg_u32 s38, 2
  s_cbranch_scc1 L_notpark_24
  v_and_b32 v52, 31, v1
  v_lshlrev_b32 v52, 2, v52
  s_and_b32 s48, s28, 3
  s_mul_i32 s48, s48, 640
  s_add_u32 s48, s48, 156800
  v_add_u32 v52, s48, v52
  v_add_f32 v80, v80, v81
  v_add_f32 v82, v82, v83
  v_add_f32 v84, v84, v85
  v_mov_b32 v81, v80
  v_mov_b32 v83, v82
  v_mov_b32 v85, v84
  s_nop 0
  v_permlane32_swap_b32 v81, v80
  v_permlane32_swap_b32 v83, v82
  v_permlane32_swap_b32 v85, v84
  v_add_f32 v80, v80, v81
  v_add_f32 v82, v82, v83
  v_add_f32 v84, v84, v85
  s_mov_b32 exec_hi, 0
  ds_write_b32 v52, v80 offset:0
  ds_write_b32 v52, v82 offset:128
  ds_write_b32 v52, v84 offset:512
  s_mov_b64 exec, -1
  s_mov_b32 s12, 9
L_notpark_24:
  s_add_u32 s38, s38, 1
  s_branch L_cloop_KV0
L_last_12:
  s_waitcnt lgkmcnt(7)
  s_cmp_lg_u32 s12, 2
  s_cbranch_scc1 L_plain_25
  s_cmp_eq_u32 s38, 1
  s_cbranch_scc1 L_cst1_28
  s_cmp_eq_u32 s38, 2
  s_cbranch_scc1 L_cst2_29
L_cst0_27:
  v_mfma_f32_32x32x16_bf16 v[4:19], v[140:143], v[136:139], v[4:19]
  v_and_b32 v52, s34, v140
  v_lshlrev_b32 v53, 16, v140
  v_and_b32 v54, s34, v141
  v_lshlrev_b32 v55, 16, v141
  v_add_f32 v80, v80, v52
  v_add_f32 v81, v81, v53
  v_mfma_f32_32x32x16_bf16 v[20:35], v[144:147], v[136:139], v[20:35]
  v_add_f32 v80, v80, v54
  v_add_f32 v81, v81, v55
  v_and_b32 v52, s34, v142
  v_lshlrev_b32 v53, 16, v142
  v_and_b32 v54, s34, v143
  v_lshlrev_b32 v55, 16, v143
  v_mfma_f32_32x32x16_bf16 v[36:51], v[148:151], v[136:139], v[36:51]
  v_add_f32 v80, v80, v52
  v_add_f32 v81, v81, v53
  v_add_f32 v80, v80, v54
  v_add_f32 v81, v81, v55
  s_branch L_stepdone_26
L_cst1_28:
  v_mfma_f32_32x32x16_bf16 v[4:19], v[140:143], v[136:139], v[4:19]
  v_and_b32 v52, s34, v144
  v_lshlrev_b32 v53, 16, v144
  v_and_b32 v54, s34, v145
  v_lshlrev_b32 v55, 16, v145
  v_add_f32 v82, v82, v52
  v_add_f32 v83, v83, v53
  v_mfma_f32_32x32x16_bf16 v[20:35], v[144:147], v[136:139], v[20:35]
  v_add_f32 v82, v82, v54
  v_add_f32 v83, v83, v55
  v_and_b32 v52, s34, v146
  v_lshlrev_b32 v53, 16, v146
  v_and_b32 v54, s34, v147
  v_lshlrev_b32 v55, 16, v147
  v_mfma_f32_32x32x16_bf16 v[36:51], v[148:151], v[136:139], v[36:51]
  v_add_f32 v82, v82, v52
  v_add_f32 v83, v83, v53
  v_add_f32 v82, v82, v54
  v_add_f32 v83, v83, v55
  s_branch L_stepdone_26
L_cst2_29:
  v_mfma_f32_32x32x16_bf16 v[4:19], v[140:143], v[136:139], v[4:19]
  v_and_b32 v52, s34, v148
  v_lshlrev_b32 v53, 16, v148
  v_and_b32 v54, s34, v149
  v_lshlrev_b32 v55, 16, v149
  v_add_f32 v84, v84, v52
  v_add_f32 v85, v85, v53
  v_mfma_f32_32x32x16_bf16 v[20:35], v[144:147], v[136:139], v[20:35]
  v_add_f32 v84, v84, v54
  v_add_f32 v85, v85, v55
  v_and_b32 v52, s34, v150
  v_lshlrev_b32 v53, 16, v150
  v_and_b32 v54, s34, v151
  v_lshlrev_b32 v55, 16, v151
  v_mfma_f32_32x32x16_bf16 v[36:51], v[148:151], v[136:139], v[36:51]
  v_add_f32 v84, v84, v52
  v_add_f32 v85, v85, v53
  v_add_f32 v84, v84, v54
  v_add_f32 v85, v85, v55
  s_branch L_stepdone_26
L_plain_25:
  v_mfma_f32_32x32x16_bf16 v[4:19], v[140:143], v[136:139], v[4:19]
  v_mfma_f32_32x32x16_bf16 v[20:35], v[144:147], v[136:139], v[20:35]
  v_mfma_f32_32x32x16_bf16 v[36:51], v[148:151], v[136:139], v[36:51]
L_stepdone_26:
  s_waitcnt lgkmcnt(0)
  s_cmp_lg_u32 s12, 3
  s_cbranch_scc1 L_plain_30
  s_cmp_eq_u32 s38, 1
  s_cbranch_scc1 L_cst1_33
  s_cmp_eq_u32 s38, 2
  s_cbranch_scc1 L_cst2_34
L_cst0_32:
  v_mfma_f32_32x32x16_bf16 v[4:19], v[156:159], v[152:155], v[4:19]
  v_and_b32 v52, s34, v156
  v_lshlrev_b32 v53, 16, v156
  v_and_b32 v54, s34, v157
  v_lshlrev_b32 v55, 16, v157
  v_add_f32 v80, v80, v52
  v_add_f32 v81, v81, v53
  v_mfma_f32_32x32x16_bf16 v[20:35], v[160:163], v[152:155], v[20:35]
  v_add_f32 v80, v80, v54
  v_add_f32 v81, v81, v55
  v_and_b32 v52, s34, v158
  v_lshlrev_b32 v53, 16, v158
  v_and_b32 v54, s34, v159
  v_lshlrev_b32 v55, 16, v159
  v_mfma_f32_32x32x16_bf16 v[36:51], v[164:167], v[152:155], v[36:51]
  v_add_f32 v80, v80, v52
  v_add_f32 v81, v81, v53
  v_add_f32 v80, v80, v54
  v_add_f32 v81, v81, v55
  s_branch L_stepdone_31
L_cst1_33:
  v_mfma_f32_32x32x16_bf16 v[4:19], v[156:159], v[152:155], v[4:19]
  v_and_b32 v52, s34, v160
  v_lshlrev_b32 v53, 16, v160
  v_and_b32 v54, s34, v161
  v_lshlrev_b32 v55, 16, v161
  v_add_f32 v82, v82, v52
  v_add_f32 v83, v83, v53
  v_mfma_f32_32x32x16_bf16 v[20:35], v[160:163], v[152:155], v[20:35]
  v_add_f32 v82, v82, v54
  v_add_f32 v83, v83, v55
  v_and_b32 v52, s34, v162
  v_lshlrev_b32 v53, 16, v162
  v_and_b32 v54, s34, v163
  v_lshlrev_b32 v55, 16, v163
  v_mfma_f32_32x32x16_bf16 v[36:51], v[164:167], v[152:155], v[36:51]
  v_add_f32 v82, v82, v52
  v_add_f32 v83, v83, v53
  v_add_f32 v82, v82, v54
  v_add_f32 v83, v83, v55
  s_branch L_stepdone_31
L_cst2_34:
  v_mfma_f32_32x32x16_bf16 v[4:19], v[156:159], v[152:155], v[4:19]
  v_and_b32 v52, s34, v164
  v_lshlrev_b32 v53, 16, v164
  v_and_b32 v54, s34, v165
  v_lshlrev_b32 v55, 16, v165
  v_add_f32 v84, v84, v52
  v_add_f32 v85, v85, v53
  v_mfma_f32_32x32x16_bf16 v[20:35], v[160:163], v[152:155], v[20:35]
  v_add_f32 v84, v84, v54
  v_add_f32 v85, v85, v55
  v_and_b32 v52, s34, v166
  v_lshlrev_b32 v53, 16, v166
  v_and_b32 v54, s34, v167
  v_lshlrev_b32 v55, 16, v167
  v_mfma_f32_32x32x16_bf16 v[36:51], v[164:167], v[152:155], v[36:51]
  v_add_f32 v84, v84, v52
  v_add_f32 v85, v85, v53
  v_add_f32 v84, v84, v54
  v_add_f32 v85, v85, v55
  s_branch L_stepdone_31
L_plain_30:
  v_mfma_f32_32x32x16_bf16 v[4:19], v[156:159], v[152:155], v[4:19]
  v_mfma_f32_32x32x16_bf16 v[20:35], v[160:163], v[152:155], v[20:35]
  v_mfma_f32_32x32x16_bf16 v[36:51], v[164:167], v[152:155], v[36:51]
L_stepdone_31:
  s_waitcnt vmcnt(0)
  ds_read_b64_tr_b16 v[52:53], v94 offset:0
  ds_read_b64_tr_b16 v[54:55], v94 offset:160
  ds_read_b64_tr_b16 v[56:57], v94 offset:320
  ds_read_b64_tr_b16 v[58:59], v94 offset:480
  ds_read_b64_tr_b16 v[60:61], v96
  v_mov_b32 v62, 0
  v_mov_b32 v63, 0
  ds_read_b64_tr_b16 v[64:65], v95 offset:0
  ds_read_b64_tr_b16 v[66:67], v95 offset:160
  ds_read_b64_tr_b16 v[68:69], v95 offset:320
  ds_read_b64_tr_b16 v[70:71], v95 offset:480
  ds_read_b64_tr_b16 v[72:73], v97
  v_mov_b32 v74, 0
  v_mov_b32 v75, 0
  s_and_b32 s48, s28, 3
  s_lshl_b32 s48, s48, 11
  s_add_u32 s48, s48, 73728
  v_lshlrev_b32 v3, 5, v1
  v_add_u32 v3, s48, v3
  ds_write_b128 v3, v[44:47]
  ds_write_b128 v3, v[48:51] offset:16
  s_waitcnt lgkmcnt(0)
  s_barrier
  v_and_b32 v104, 31, v1
  v_lshlrev_b32 v104, 4, v104
  v_add_u32 v104, 159296, v104
  ds_read_b128 v[108:111], v104 offset:0
  ds_read_b128 v[112:115], v104 offset:512
  ds_read_b128 v[116:119], v104 offset:2048
  s_mov_b32 s50, 0
L_stat_again_35:
  v_cmp_ne_u32 vcc, s29, v77
  v_cmp_ne_u32 s[48:49], s29, v79
  s_nop 1
  s_or_b64 vcc, vcc, s[48:49]
  s_cbranch_vccz L_stat_ok_36
  s_add_u32 s50, s50, 1
  s_cmp_gt_u32 s50, 40000
  s_cbranch_scc1 L_stat_ok_36
  buffer_load_dwordx4 v[76:79], v103, s[64:67], 0 offen sc1
  s_waitcnt vmcnt(0)
  s_branch L_stat_again_35
L_stat_ok_36:
  v_sub_f32 v105, 0, v76
  v_cvt_pk_bf16_f32 v106, v105, v105
  v_lshlrev_b32 v107, 16, v106
  v_sub_f32 v107, v105, v107
  v_cvt_pk_bf16_f32 v107, v107, v107
  v_cmp_gt_u32 vcc, 32, v1
  s_nop 1
  v_cndmask_b32 v120, v107, v106, vcc
  v_cndmask_b32 v122, 0, v106, vcc
  v_mov_b32 v121, v120
  v_mov_b32 v123, v122
  s_waitcnt lgkmcnt(2)
  s_nop 0
  v_mfma_f32_32x32x16_bf16 v[4:19], v[108:111], v[120:123], v[4:19]
  s_waitcnt lgkmcnt(1)
  v_mfma_f32_32x32x16_bf16 v[20:35], v[112:115], v[120:123], v[20:35]
  s_waitcnt lgkmcnt(0)
  v_mfma_f32_32x32x16_bf16 v[36:51], v[116:119], v[120:123], v[36:51]
  s_branch L_c2_KV
L_c1_KV:
  s_lshr_b32 s12, s28, 1
  s_and_b32 s12, s12, 2
  s_add_u32 s12, s12, s28
  s_and_b32 s12, s12, 3
  s_mov_b32 s38, 0
  s_mov_b32 s41, 0
  s_barrier
  ds_read_b128 v[104:107], v86
  ds_read_b64_tr_b16 v[108:109], v90 offset:0
  ds_read_b64_tr_b16 v[110:111], v90 offset:1280
  ds_read_b64_tr_b16 v[112:113], v90 offset:64
  ds_read_b64_tr_b16 v[114:115], v90 offset:1344
  ds_read_b128 v[120:123], v87
  ds_read_b64_tr_b16 v[124:125], v90 offset:5120
  ds_read_b64_tr_b16 v[126:127], v90 offset:6400
  ds_read_b64_tr_b16 v[128:129], v90 offset:5184
  ds_read_b64_tr_b16 v[130:131], v90 offset:6464
L_cloop_KV1:
  s_waitcnt lgkmcnt(5)
  s_cmp_lg_u32 s12, 0
  s_cbranch_scc1 L_plain_37
  s_cmp_eq_u32 s38, 1
  s_cbranch_scc1 L_cst1_40
L_cst0_39:
  v_mfma_f32_32x32x16_bf16 v[4:19], v[108:111], v[104:107], v[4:19]
  ds_read_b128 v[136:139], v88
  ds_read_b64_tr_b16 v[140:141], v90 offset:10240
  ds_read_b64_tr_b16 v[142:143], v90 offset:11520
  v_and_b32 v52, s34, v108
  v_lshlrev_b32 v53, 16, v108
  v_and_b32 v54, s34, v109
  v_lshlrev_b32 v55, 16, v109
  v_add_f32 v80, v80, v52
  v_add_f32 v81, v81, v53
  v_add_f32 v80, v80, v54
  v_add_f32 v81, v81, v55
  v_mfma_f32_32x32x16_bf16 v[20:35], v[112:115], v[104:107], v[20:35]
  ds_read_b64_tr_b16 v[144:145], v90 offset:10304
  ds_read_b64_tr_b16 v[146:147], v90 offset:11584
  v_and_b32 v52, s34, v110
  v_lshlrev_b32 v53, 16, v110
  v_and_b32 v54, s34, v111
  v_lshlrev_b32 v55, 16, v111
  v_add_f32 v80, v80, v52
  v_add_f32 v81, v81, v53
  v_add_f32 v80, v80, v54
  v_add_f32 v81, v81, v55
  s_branch L_stepdone_38
L_cst1_40:
  v_mfma_f32_32x32x16_bf16 v[4:19], v[108:111], v[104:107], v[4:19]
  ds_read_b128 v[136:139], v88
  ds_read_b64_tr_b16 v[140:141], v90 offset:10240
  ds_read_b64_tr_b16 v[142:143], v90 offset:11520
  v_and_b32 v52, s34, v112
  v_lshlrev_b32 v53, 16, v112
  v_and_b32 v54, s34, v113
  v_lshlrev_b32 v55, 16, v113
  v_add_f32 v82, v82, v52
  v_add_f32 v83, v83, v53
  v_add_f32 v82, v82, v54
  v_add_f32 v83, v83, v55
  v_mfma_f32_32x32x16_bf16 v[20:35], v[112:115], v[104:107], v[20:35]
  ds_read_b64_tr_b16 v[144:145], v90 offset:10304
  ds_read_b64_tr_b16 v[146:147], v90 offset:11584
  v_and_b32 v52, s34, v114
  v_lshlrev_b32 v53, 16, v114
  v_and_b32 v54, s34, v115
  v_lshlrev_b32 v55, 16, v115
  v_add_f32 v82, v82, v52
  v_add_f32 v83, v83, v53
  v_add_f32 v82, v82, v54
  v_add_f32 v83, v83, v55
  s_branch L_stepdone_38
L_plain_37:
  v_mfma_f32_32x32x16_bf16 v[4:19], v[108:111], v[104:107], v[4:19]
  ds_read_b128 v[136:139], v88
  ds_read_b64_tr_b16 v[140:141], v90 offset:10240
  ds_read_b64_tr_b16 v[142:143], v90 offset:11520
  v_mfma_f32_32x32x16_bf16 v[20:35], v[112:115], v[104:107], v[20:35]
  ds_read_b64_tr_b16 v[144:145], v90 offset:10304
  ds_read_b64_tr_b16 v[146:147], v90 offset:11584
L_stepdone_38:
  s_waitcnt lgkmcnt(5)
  s_cmp_lg_u32 s12, 1
  s_cbranch_scc1 L_plain_41
  s_cmp_eq_u32 s38, 1
  s_cbranch_scc1 L_cst1_44
L_cst0_43:
  v_mfma_f32_32x32x16_bf16 v[4:19], v[124:127], v[120:123], v[4:19]
  ds_read_b128 v[152:155], v89
  ds_read_b64_tr_b16 v[156:157], v90 offset:15360
  ds_read_b64_tr_b16 v[158:159], v90 offset:16640
  v_and_b32 v52, s34, v124
  v_lshlrev_b32 v53, 16, v124
  v_and_b32 v54, s34, v125
  v_lshlrev_b32 v55, 16, v125
  v_add_f32 v80, v80, v52
  v_add_f32 v81, v81, v53
  v_add_f32 v80, v80, v54
  v_add_f32 v81, v81, v55
  v_mfma_f32_32x32x16_bf16 v[20:35], v[128:131], v[120:123], v[20:35]
  ds_read_b64_tr_b16 v[160:161], v90 offset:15424
  ds_read_b64_tr_b16 v[162:163], v90 offset:16704
  v_and_b32 v52, s34, v126
  v_lshlrev_b32 v53, 16, v126
  v_and_b32 v54, s34, v127
  v_lshlrev_b32 v55, 16, v127
  v_add_f32 v80, v80, v52
  v_add_f32 v81, v81, v53
  v_add_f32 v80, v80, v54
  v_add_f32 v81, v81, v55
  s_branch L_stepdone_42
L_cst1_44:
  v_mfma_f32_32x32x16_bf16 v[4:19], v[124:127], v[120:123], v[4:19]
  ds_read_b128 v[152:155], v89
  ds_read_b64_tr_b16 v[156:157], v90 offset:15360
  ds_read_b64_tr_b16 v[158:159], v90 offset:16640
  v_and_b32 v52, s34, v128
  v_lshlrev_b32 v53, 16, v128
  v_and_b32 v54, s34, v129
  v_lshlrev_b32 v55, 16, v129
  v_add_f32 v82, v82, v52
  v_add_f32 v83, v83, v53
  v_add_f32 v82, v82, v54
  v_add_f32 v83, v83, v55
  v_mfma_f32_32x32x16_bf16 v[20:35], v[128:131], v[120:123], v[20:35]
  ds_read_b64_tr_b16 v[160:161], v90 offset:15424
  ds_read_b64_tr_b16 v[162:163], v90 offset:16704
  v_and_b32 v52, s34, v130
  v_lshlrev_b32 v53, 16, v130
  v_and_b32 v54, s34, v131
  v_lshlrev_b32 v55, 16, v131
  v_add_f32 v82, v82, v52
  v_add_f32 v83, v83, v53
  v_add_f32 v82, v82, v54
  v_add_f32 v83, v83, v55
  s_branch L_stepdone_42
L_plain_41:
  v_mfma_f32_32x32x16_bf16 v[4:19], v[124:127], v[120:123], v[4:19]
  ds_read_b128 v[152:155], v89
  ds_read_b64_tr_b16 v[156:157], v90 offset:15360
  ds_read_b64_tr_b16 v[158:159], v90 offset:16640
  v_mfma_f32_32x32x16_bf16 v[20:35], v[128:131], v[120:123], v[20:35]
  ds_read_b64_tr_b16 v[160:161], v90 offset:15424
  ds_read_b64_tr_b16 v[162:163], v90 offset:16704
L_stepdone_42:
  s_cmp_eq_u32 s38, 9
  s_cbranch_scc1 L_last_45
  s_cmp_lg_u32 s38, 6
  s_cbranch_scc1 L_nostat_46
  buffer_load_dwordx4 v[76:79], v103, s[64:67], 0 offen sc1
L_nostat_46:
  s_add_u32 s41, s41, 36864
  s_cmp_eq_u32 s41, 147456
  s_cselect_b32 s41, 0, s41
  s_mov_b32 s42, 36864
  s_cselect_b32 s42, 4294856704, s42
  v_add_u32 v86, s42, v86
  v_add_u32 v87, s42, v87
  v_add_u32 v88, s42, v88
  v_add_u32 v89, s42, v89
  v_add_u32 v90, s42, v90
  s_barrier
  s_waitcnt lgkmcnt(5)
  s_cmp_lg_u32 s12, 2
  s_cbranch_scc1 L_plain_47
  s_cmp_eq_u32 s38, 1
  s_cbranch_scc1 L_cst1_50
L_cst0_49:
  v_mfma_f32_32x32x16_bf16 v[4:19], v[140:143], v[136:139], v[4:19]
  ds_read_b128 v[104:107], v86
  ds_read_b64_tr_b16 v[108:109], v90 offset:0
  ds_read_b64_tr_b16 v[110:111], v90 offset:1280
  v_and_b32 v52, s34, v140
  v_lshlrev_b32 v53, 16, v140
  v_and_b32 v54, s34, v141
  v_lshlrev_b32 v55, 16, v141
  v_add_f32 v80, v80, v52
  v_add_f32 v81, v81, v53
  v_add_f32 v80, v80, v54
  v_add_f32 v81, v81, v55
  v_mfma_f32_32x32x16_bf16 v[20:35], v[144:147], v[136:139], v[20:35]
  ds_read_b64_tr_b16 v[112:113], v90 offset:64
  ds_read_b64_tr_b16 v[114:115], v90 offset:1344
  v_and_b32 v52, s34, v142
  v_lshlrev_b32 v53, 16, v142
  v_and_b32 v54, s34, v143
  v_lshlrev_b32 v55, 16, v143
  v_add_f32 v80, v80, v52
  v_add_f32 v81, v81, v53
  v_add_f32 v80, v80, v54
  v_add_f32 v81, v81, v55
  s_branch L_stepdone_48
L_cst1_50:
  v_mfma_f32_32x32x16_bf16 v[4:19], v[140:143], v[136:139], v[4:19]
  ds_read_b128 v[104:107], v86
  ds_read_b64_tr_b16 v[108:109], v90 offset:0
  ds_read_b64_tr_b16 v[110:111], v90 offset:1280
  v_and_b32 v52, s34, v144
  v_lshlrev_b32 v53, 16, v144
  v_and_b32 v54, s34, v145
  v_lshlrev_b32 v55, 16, v145
  v_add_f32 v82, v82, v52
  v_add_f32 v83, v83, v53
  v_add_f32 v82, v82, v54
  v_add_f32 v83, v83, v55
  v_mfma_f32_32x32x16_bf16 v[20:35], v[144:147], v[136:139], v[20:35]
  ds_read_b64_tr_b16 v[112:113], v90 offset:64
  ds_read_b64_tr_b16 v[114:115], v90 offset:1344
  v_and_b32 v52, s34, v146
  v_lshlrev_b32 v53, 16, v146
  v_and_b32 v54, s34, v147
  v_lshlrev_b32 v55, 16, v147
  v_add_f32 v82, v82, v52
  v_add_f32 v83, v83, v53
  v_add_f32 v82, v82, v54
  v_add_f32 v83, v83, v55
  s_branch L_stepdone_48
L_plain_47:
  v_mfma_f32_32x32x16_bf16 v[4:19], v[140:143], v[136:139], v[4:19]
  ds_read_b128 v[104:107], v86
  ds_read_b64_tr_b16 v[108:109], v90 offset:0
  ds_read_b64_tr_b16 v[110:111], v90 offset:1280
  v_mfma_f32_32x32x16_bf16 v[20:35], v[144:147], v[136:139], v[20:35]
  ds_read_b64_tr_b16 v[112:113], v90 offset:64
  ds_read_b64_tr_b16 v[114:115], v90 offset:1344
L_stepdone_48:
  s_waitcnt lgkmcnt(5)
  s_cmp_lg_u32 s12, 3
  s_cbranch_scc1 L_plain_51
  s_cmp_eq_u32 s38, 1
  s_cbranch_scc1 L_cst1_54
L_cst0_53:
  v_mfma_f32_32x32x16_bf16 v[4:19], v[156:159], v[152:155], v[4:19]
  ds_read_b128 v[120:123], v87
  ds_read_b64_tr_b16 v[124:125], v90 offset:5120
  ds_read_b64_tr_b16 v[126:127], v90 offset:6400
  v_and_b32 v52, s34, v156
  v_lshlrev_b32 v53, 16, v156
  v_and_b32 v54, s34, v157
  v_lshlrev_b32 v55, 16, v157
  v_add_f32 v80, v80, v52
  v_add_f32 v81, v81, v53
  v_add_f32 v80, v80, v54
  v_add_f32 v81, v81, v55
  v_mfma_f32_32x32x16_bf16 v[20:35], v[160:163], v[152:155], v[20:35]
  ds_read_b64_tr_b16 v[128:129], v90 offset:5184
  ds_read_b64_tr_b16 v[130:131], v90 offset:6464
  v_and_b32 v52, s34, v158
  v_lshlrev_b32 v53, 16, v158
  v_and_b32 v54, s34, v159
  v_lshlrev_b32 v55, 16, v159
  v_add_f32 v80, v80, v52
  v_add_f32 v81, v81, v53
  v_add_f32 v80, v80, v54
  v_add_f32 v81, v81, v55
  s_branch L_stepdone_52
L_cst1_54:
  v_mfma_f32_32x32x16_bf16 v[4:19], v[156:159], v[152:155], v[4:19]
  ds_read_b128 v[120:123], v87
  ds_read_b64_tr_b16 v[124:125], v90 offset:5120
  ds_read_b64_tr_b16 v[126:127], v90 offset:6400
  v_and_b32 v52, s34, v160
  v_lshlrev_b32 v53, 16, v160
  v_and_b32 v54, s34, v161
  v_lshlrev_b32 v55, 16, v161
  v_add_f32 v82, v82, v52
  v_add_f32 v83, v83, v53
  v_add_f32 v82, v82, v54
  v_add_f32 v83, v83, v55
  v_mfma_f32_32x32x16_bf16 v[20:35], v[160:163], v[152:155], v[20:35]
  ds_read_b64_tr_b16 v[128:129], v90 offset:5184
  ds_read_b64_tr_b16 v[130:131], v90 offset:6464
  v_and_b32 v52, s34, v162
  v_lshlrev_b32 v53, 16, v162
  v_and_b32 v54, s34, v163
  v_lshlrev_b32 v55, 16, v163
  v_add_f32 v82, v82, v52
  v_add_f32 v83, v83, v53
  v_add_f32 v82, v82, v54
  v_add_f32 v83, v83, v55
  s_branch L_stepdone_52
L_plain_51:
  v_mfma_f32_32x32x16_bf16 v[4:19], v[156:159], v[152:155], v[4:19]
  ds_read_b128 v[120:123], v87
  ds_read_b64_tr_b16 v[124:125], v90 offset:5120
  ds_read_b64_tr_b16 v[126:127], v90 offset:6400
  v_mfma_f32_32x32x16_bf16 v[20:35], v[160:163], v[152:155], v[20:35]
  ds_read_b64_tr_b16 v[128:129], v90 offset:5184
  ds_read_b64_tr_b16 v[130:131], v90 offset:6464
L_stepdone_52:
  s_cmp_lg_u32 s38, 1
  s_cbranch_scc1 L_keepsum_55
  s_mov_b32 s12, 9
L_keepsum_55:
  s_cmp_lg_u32 s38, 2
  s_cbranch_scc1 L_notpark_56
  v_and_b32 v52, 31, v1
  v_lshlrev_b32 v52, 2, v52
  s_and_b32 s48, s28, 3
  s_mul_i32 s48, s48, 640
  s_add_u32 s48, s48, 156800
  v_add_u32 v52, s48, v52
  v_add_f32 v80, v80, v81
  v_add_f32 v82, v82, v83
  v_mov_b32 v81, v80
  v_mov_b32 v83, v82
  s_nop 0
  v_permlane32_swap_b32 v81, v80
  v_permlane32_swap_b32 v83, v82
  v_add_f32 v80, v80, v81
  v_add_f32 v82, v82, v83
  s_mov_b32 exec_hi, 0
  ds_write_b32 v52, v80 offset:256
  ds_write_b32 v52, v82 offset:384
  s_mov_b64 exec, -1
  s_mov_b32 s12, 9
L_notpark_56:
  s_add_u32 s38, s38, 1
  s_branch L_cloop_KV1
L_last_45:
  s_waitcnt lgkmcnt(5)
  s_cmp_lg_u32 s12, 2
  s_cbranch_scc1 L_plain_57
  s_cmp_eq_u32 s38, 1
  s_cbranch_scc1 L_cst1_60
L_cst0_59:
  v_mfma_f32_32x32x16_bf16 v[4:19], v[140:143], v[136:139], v[4:19]
  v_and_b32 v52, s34, v140
  v_lshlrev_b32 v53, 16, v140
  v_and_b32 v54, s34, v141
  v_lshlrev_b32 v55, 16, v141
  v_add_f32 v80, v80, v52
  v_add_f32 v81, v81, v53
  v_add_f32 v80, v80, v54
  v_add_f32 v81, v81, v55
  v_mfma_f32_32x32x16_bf16 v[20:35], v[144:147], v[136:139], v[20:35]
  v_and_b32 v52, s34, v142
  v_lshlrev_b32 v53, 16, v142
  v_and_b32 v54, s34, v143
  v_lshlrev_b32 v55, 16, v143
  v_add_f32 v80, v80, v52
  v_add_f32 v81, v81, v53
  v_add_f32 v80, v80, v54
  v_add_f32 v81, v81, v55
  s_branch L_stepdone_58
L_cst1_60:
  v_mfma_f32_32x32x16_bf16 v[4:19], v[140:143], v[136:139], v[4:19]
  v_and_b32 v52, s34, v144
  v_lshlrev_b32 v53, 16, v144
  v_and_b32 v54, s34, v145
  v_lshlrev_b32 v55, 16, v145
  v_add_f32 v82, v82, v52
  v_add_f32 v83, v83, v53
  v_add_f32 v82, v82, v54
  v_add_f32 v83, v83, v55
  v_mfma_f32_32x32x16_bf16 v[20:35], v[144:147], v[136:139], v[20:35]
  v_and_b32 v52, s34, v146
  v_lshlrev_b32 v53, 16, v146
  v_and_b32 v54, s34, v147
  v_lshlrev_b32 v55, 16, v147
  v_add_f32 v82, v82, v52
  v_add_f32 v83, v83, v53
  v_add_f32 v82, v82, v54
  v_add_f32 v83, v83, v55
  s_branch L_stepdone_58
L_plain_57:
  v_mfma_f32_32x32x16_bf16 v[4:19], v[140:143], v[136:139], v[4:19]
  v_mfma_f32_32x32x16_bf16 v[20:35], v[144:147], v[136:139], v[20:35]
L_stepdone_58:
  s_waitcnt lgkmcnt(0)
  s_cmp_lg_u32 s12, 3
  s_cbranch_scc1 L_plain_61
  s_cmp_eq_u32 s38, 1
  s_cbranch_scc1 L_cst1_64
L_cst0_63:
  v_mfma_f32_32x32x16_bf16 v[4:19], v[156:159], v[152:155], v[4:19]
  v_and_b32 v52, s34, v156
  v_lshlrev_b32 v53, 16, v156
  v_and_b32 v54, s34, v157
  v_lshlrev_b32 v55, 16, v157
  v_add_f32 v80, v80, v52
  v_add_f32 v81, v81, v53
  v_add_f32 v80, v80, v54
  v_add_f32 v81, v81, v55
  v_mfma_f32_32x32x16_bf16 v[20:35], v[160:163], v[152:155], v[20:35]
  v_and_b32 v52, s34, v158
  v_lshlrev_b32 v53, 16, v158
  v_and_b32 v54, s34, v159
  v_lshlrev_b32 v55, 16, v159
  v_add_f32 v80, v80, v52
  v_add_f32 v81, v81, v53
  v_add_f32 v80, v80, v54
  v_add_f32 v81, v81, v55
  s_branch L_stepdone_62
L_cst1_64:
  v_mfma_f32_32x32x16_bf16 v[4:19], v[156:159], v[152:155], v[4:19]
  v_and_b32 v52, s34, v160
  v_lshlrev_b32 v53, 16, v160
  v_and_b32 v54, s34, v161
  v_lshlrev_b32 v55, 16, v161
  v_add_f32 v82, v82, v52
  v_add_f32 v83, v83, v53
  v_add_f32 v82, v82, v54
  v_add_f32 v83, v83, v55
  v_mfma_f32_32x32x16_bf16 v[20:35], v[160:163], v[152:155], v[20:35]
  v_and_b32 v52, s34, v162
  v_lshlrev_b32 v53, 16, v162
  v_and_b32 v54, s34, v163
  v_lshlrev_b32 v55, 16, v163
  v_add_f32 v82, v82, v52
  v_add_f32 v83, v83, v53
  v_add_f32 v82, v82, v54
  v_add_f32 v83, v83, v55
  s_branch L_stepdone_62
L_plain_61:
  v_mfma_f32_32x32x16_bf16 v[4:19], v[156:159], v[152:155], v[4:19]
  v_mfma_f32_32x32x16_bf16 v[20:35], v[160:163], v[152:155], v[20:35]
L_stepdone_62:
  s_waitcnt vmcnt(0)
  ds_read_b64_tr_b16 v[52:53], v94 offset:0
  ds_read_b64_tr_b16 v[54:55], v94 offset:160
  ds_read_b64_tr_b16 v[56:57], v94 offset:320
  ds_read_b64_tr_b16 v[58:59], v94 offset:480
  ds_read_b64_tr_b16 v[60:61], v96
  v_mov_b32 v62, 0
  v_mov_b32 v63, 0
  ds_read_b64_tr_b16 v[64:65], v95 offset:0
  ds_read_b64_tr_b16 v[66:67], v95 offset:160
  ds_read_b64_tr_b16 v[68:69], v95 offset:320
  ds_read_b64_tr_b16 v[70:71], v95 offset:480
  ds_read_b64_tr_b16 v[72:73], v97
  v_mov_b32 v74, 0
  v_mov_b32 v75, 0
  s_barrier
  v_and_b32 v104, 31, v1
  v_lshlrev_b32 v104, 4, v104
  v_add_u32 v104, 159296, v104
  ds_read_b128 v[108:111], v104 offset:1024
  ds_read_b128 v[112:115], v104 offset:1536
  ds_read_b128 v[116:119], v104 offset:2304
  s_and_b32 s48, s28, 3
  s_lshl_b32 s48, s48, 11
  s_add_u32 s48, s48, 73728
  v_lshlrev_b32 v104, 5, v1
  v_add_u32 v104, s48, v104
  ds_read_b128 v[36:39], v104
  ds_read_b128 v[40:43], v104 offset:16
  s_mov_b32 s50, 0
L_stat_again_65:
  v_cmp_ne_u32 vcc, s29, v77
  v_cmp_ne_u32 s[48:49], s29, v79
  s_nop 1
  s_or_b64 vcc, vcc, s[48:49]
  s_cbranch_vccz L_stat_ok_66
  s_add_u32 s50, s50, 1
  s_cmp_gt_u32 s50, 40000
  s_cbranch_scc1 L_stat_ok_66
  buffer_load_dwordx4 v[76:79], v103, s[64:67], 0 offen sc1
  s_waitcnt vmcnt(0)
  s_branch L_stat_again_65
L_stat_ok_66:
  v_sub_f32 v105, 0, v76
  v_cvt_pk_bf16_f32 v106, v105, v105
  v_lshlrev_b32 v107, 16, v106
  v_sub_f32 v107, v105, v107
  v_cvt_pk_bf16_f32 v107, v107, v107
  v_cmp_gt_u32 vcc, 32, v1
  s_nop 1
  v_cndmask_b32 v120, v107, v106, vcc
  v_cndmask_b32 v122, 0, v106, vcc
  v_mov_b32 v121, v120
  v_mov_b32 v123, v122
  s_waitcnt lgkmcnt(4)
  s_nop 0
  v_mfma_f32_32x32x16_bf16 v[4:19], v[108:111], v[120:123], v[4:19]
  s_waitcnt lgkmcnt(3)
  v_mfma_f32_32x32x16_bf16 v[20:35], v[112:115], v[120:123], v[20:35]
  s_waitcnt lgkmcnt(0)
  v_mfma_f32_32x32x16_bf16 v[36:51], v[116:119], v[120:123], v[36:51]
L_c2_KV:
  s_nop 7
  v_cvt_pk_bf16_f32 v80, v4, v5
  v_cvt_pk_bf16_f32 v81, v6, v7
  v_cvt_pk_bf16_f32 v82, v8, v9
  v_cvt_pk_bf16_f32 v83, v10, v11
  v_cvt_pk_bf16_f32 v84, v12, v13
  v_cvt_pk_bf16_f32 v85, v14, v15
  v_cvt_pk_bf16_f32 v86, v16, v17
  v_cvt_pk_bf16_f32 v87, v18, v19
  v_cvt_pk_bf16_f32 v88, v36, v37
  v_cvt_pk_bf16_f32 v89, v38, v39
  v_mov_b32 v90, 0
  v_mov_b32 v91, 0
  v_mfma_f32_32x32x16_bf16 v[120:135], v[64:67], v[80:83], 0
  v_mfma_f32_32x32x16_bf16 v[104:119], v[52:55], v[80:83], 0
  v_mfma_f32_32x32x16_bf16 v[120:135], v[68:71], v[84:87], v[120:135]
  v_mfma_f32_32x32x16_bf16 v[104:119], v[56:59], v[84:87], v[104:119]
  v_mfma_f32_32x32x16_bf16 v[120:135], v[72:75], v[88:91], v[120:135]
  v_mfma_f32_32x32x16_bf16 v[104:119], v[60:63], v[88:91], v[104:119]
  v_rcp_f32 v3, v78
  v_cvt_pk_bf16_f32 v136, v20, v21
  v_cvt_pk_bf16_f32 v137, v22, v23
  v_cvt_pk_bf16_f32 v138, v24, v25
  v_cvt_pk_bf16_f32 v139, v26, v27
  v_cvt_pk_bf16_f32 v140, v28, v29
  v_cvt_pk_bf16_f32 v141, v30, v31
  v_cvt_pk_bf16_f32 v142, v32, v33
  v_cvt_pk_bf16_f32 v143, v34, v35
  v_cvt_pk_bf16_f32 v144, v40, v41
  v_cvt_pk_bf16_f32 v145, v42, v43
  v_cvt_pk_bf16_f32 v146, v3, 0
  v_mov_b32 v147, 0
  ds_write_b128 v99, v[136:139] offset:0
  ds_write_b128 v99, v[140:143] offset:16
  ds_write_b128 v99, v[144:147] offset:32
  v_mul_f32 v84, 0x3fb8aa3b, v78
  v_max3_f32 v80, v104, v105, v106
  v_max3_f32 v81, v107, v108, v109
  v_max3_f32 v80, v80, v110, v111
  v_max3_f32 v81, v81, v112, v113
  v_max3_f32 v80, v80, v114, v115
  v_max3_f32 v81, v81, v116, v117
  v_max3_f32 v80, v80, v118, v119
  v_max3_f32 v81, v81, v120, v121
  v_max3_f32 v80, v80, v122, v123
  v_max_f32 v80, v80, v81
  v_mul_f32 v80, v80, v84
  v_pk_fma_f32 v[148:149], v[104:105], v[84:85], v[80:81] op_sel_hi:[1,0,0] neg_lo:[0,0,1] neg_hi:[0,0,1]
  v_pk_fma_f32 v[150:151], v[106:107], v[84:85], v[80:81] op_sel_hi:[1,0,0] neg_lo:[0,0,1] neg_hi:[0,0,1]
  v_pk_fma_f32 v[152:153], v[108:109], v[84:85], v[80:81] op_sel_hi:[1,0,0] neg_lo:[0,0,1] neg_hi:[0,0,1]
  v_pk_fma_f32 v[154:155], v[110:111], v[84:85], v[80:81] op_sel_hi:[1,0,0] neg_lo:[0,0,1] neg_hi:[0,0,1]
  v_pk_fma_f32 v[156:157], v[112:113], v[84:85], v[80:81] op_sel_hi:[1,0,0] neg_lo:[0,0,1] neg_hi:[0,0,1]
  v_pk_fma_f32 v[158:159], v[114:115], v[84:85], v[80:81] op_sel_hi:[1,0,0] neg_lo:[0,0,1] neg_hi:[0,0,1]
  v_pk_fma_f32 v[160:161], v[116:117], v[84:85], v[80:81] op_sel_hi:[1,0,0] neg_lo:[0,0,1] neg_hi:[0,0,1]
  v_pk_fma_f32 v[162:163], v[118:119], v[84:85], v[80:81] op_sel_hi:[1,0,0] neg_lo:[0,0,1] neg_hi:[0,0,1]
  v_pk_fma_f32 v[164:165], v[120:121], v[84:85], v[80:81] op_sel_hi:[1,0,0] neg_lo:[0,0,1] neg_hi:[0,0,1]
  v_pk_fma_f32 v[166:167], v[122:123], v[84:85], v[80:81] op_sel_hi:[1,0,0] neg_lo:[0,0,1] neg_hi:[0,0,1]
  v_exp_f32 v148, v148
  v_exp_f32 v149, v149
  v_exp_f32 v150, v150
  v_exp_f32 v151, v151
  v_exp_f32 v152, v152
  v_exp_f32 v153, v153
  v_exp_f32 v154, v154
  v_exp_f32 v155, v155
  v_exp_f32 v156, v156
  v_exp_f32 v157, v157
  v_exp_f32 v158, v158
  v_exp_f32 v159, v159
  v_exp_f32 v160, v160
  v_exp_f32 v161, v161
  v_exp_f32 v162, v162
  v_exp_f32 v163, v163
  v_exp_f32 v164, v164
  v_exp_f32 v165, v165
  v_exp_f32 v166, v166
  v_exp_f32 v167, v167
  v_rcp_f32 v4, v148
  v_rcp_f32 v5, v149
  v_rcp_f32 v6, v150
  v_rcp_f32 v7, v151
  v_rcp_f32 v8, v152
  v_rcp_f32 v9, v153
  v_rcp_f32 v10, v154
  v_rcp_f32 v11, v155
  v_rcp_f32 v12, v156
  v_rcp_f32 v13, v157
  v_rcp_f32 v14, v158
  v_rcp_f32 v15, v159
  v_rcp_f32 v16, v160
  v_rcp_f32 v17, v161
  v_rcp_f32 v18, v162
  v_rcp_f32 v19, v163
  v_rcp_f32 v36, v164
  v_rcp_f32 v37, v165
  v_rcp_f32 v38, v166
  v_rcp_f32 v39, v167
  v_pk_add_f32 v[86:87], v[148:149], v[150:151]
  v_pk_add_f32 v[86:87], v[86:87], v[152:153]
  v_pk_add_f32 v[86:87], v[86:87], v[154:155]
  v_pk_add_f32 v[86:87], v[86:87], v[156:157]
  v_pk_add_f32 v[86:87], v[86:87], v[158:159]
  v_pk_add_f32 v[86:87], v[86:87], v[160:161]
  v_pk_add_f32 v[86:87], v[86:87], v[162:163]
  v_pk_add_f32 v[86:87], v[86:87], v[164:165]
  v_pk_add_f32 v[86:87], v[86:87], v[166:167]
  v_add_f32 v86, v86, v87
  v_pk_add_f32 v[88:89], v[4:5], v[6:7]
  v_pk_add_f32 v[88:89], v[88:89], v[8:9]
  v_pk_add_f32 v[88:89], v[88:89], v[10:11]
  v_pk_add_f32 v[88:89], v[88:89], v[12:13]
  v_pk_add_f32 v[88:89], v[88:89], v[14:15]
  v_pk_add_f32 v[88:89], v[88:89], v[16:17]
  v_pk_add_f32 v[88:89], v[88:89], v[18:19]
  v_pk_add_f32 v[88:89], v[88:89], v[36:37]
  v_pk_add_f32 v[88:89], v[88:89], v[38:39]
  v_add_f32 v88, v88, v89
  v_cmp_ngt_f32 vcc, 0x71800000, v88
  s_nop 0
  s_cbranch_vccz L_recip_ok_67
  v_min3_f32 v82, v104, v105, v106
  v_min3_f32 v83, v107, v108, v109
  v_min3_f32 v82, v82, v110, v111
  v_min3_f32 v83, v83, v112, v113
  v_min3_f32 v82, v82, v114, v115
  v_min3_f32 v83, v83, v116, v117
  v_min3_f32 v82, v82, v118, v119
  v_min3_f32 v83, v83, v120, v121
  v_min3_f32 v82, v82, v122, v123
  v_min_f32 v82, v82, v83
  v_mul_f32 v82, v82, v84
  v_pk_fma_f32 v[4:5], v[104:105], v[84:85], v[82:83] op_sel_hi:[1,0,0] neg_lo:[1,0,0] neg_hi:[1,0,0]
  v_pk_fma_f32 v[6:7], v[106:107], v[84:85], v[82:83] op_sel_hi:[1,0,0] neg_lo:[1,0,0] neg_hi:[1,0,0]
  v_pk_fma_f32 v[8:9], v[108:109], v[84:85], v[82:83] op_sel_hi:[1,0,0] neg_lo:[1,0,0] neg_hi:[1,0,0]
  v_pk_fma_f32 v[10:11], v[110:111], v[84:85], v[82:83] op_sel_hi:[1,0,0] neg_lo:[1,0,0] neg_hi:[1,0,0]
  v_pk_fma_f32 v[12:13], v[112:113], v[84:85], v[82:83] op_sel_hi:[1,0,0] neg_lo:[1,0,0] neg_hi:[1,0,0]
  v_pk_fma_f32 v[14:15], v[114:115], v[84:85], v[82:83] op_sel_hi:[1,0,0] neg_lo:[1,0,0] neg_hi:[1,0,0]
  v_pk_fma_f32 v[16:17], v[116:117], v[84:85], v[82:83] op_sel_hi:[1,0,0] neg_lo:[1,0,0] neg_hi:[1,0,0]
  v_pk_fma_f32 v[18:19], v[118:119], v[84:85], v[82:83] op_sel_hi:[1,0,0] neg_lo:[1,0,0] neg_hi:[1,0,0]
  v_pk_fma_f32 v[36:37], v[120:121], v[84:85], v[82:83] op_sel_hi:[1,0,0] neg_lo:[1,0,0] neg_hi:[1,0,0]
  v_pk_fma_f32 v[38:39], v[122:123], v[84:85], v[82:83] op_sel_hi:[1,0,0] neg_lo:[1,0,0] neg_hi:[1,0,0]
  v_exp_f32 v4, v4
  v_exp_f32 v5, v5
  v_exp_f32 v6, v6
  v_exp_f32 v7, v7
  v_exp_f32 v8, v8
  v_exp_f32 v9, v9
  v_exp_f32 v10, v10
  v_exp_f32 v11, v11
  v_exp_f32 v12, v12
  v_exp_f32 v13, v13
  v_exp_f32 v14, v14
  v_exp_f32 v15, v15
  v_exp_f32 v16, v16
  v_exp_f32 v17, v17
  v_exp_f32 v18, v18
  v_exp_f32 v19, v19
  v_exp_f32 v36, v36
  v_exp_f32 v37, v37
  v_exp_f32 v38, v38
  v_exp_f32 v39, v39
  v_pk_add_f32 v[88:89], v[4:5], v[6:7]
  v_pk_add_f32 v[88:89], v[88:89], v[8:9]
  v_pk_add_f32 v[88:89], v[88:89], v[10:11]
  v_pk_add_f32 v[88:89], v[88:89], v[12:13]
  v_pk_add_f32 v[88:89], v[88:89], v[14:15]
  v_pk_add_f32 v[88:89], v[88:89], v[16:17]
  v_pk_add_f32 v[88:89], v[88:89], v[18:19]
  v_pk_add_f32 v[88:89], v[88:89], v[36:37]
  v_pk_add_f32 v[88:89], v[88:89], v[38:39]
  v_add_f32 v88, v88, v89
L_recip_ok_67:
  v_rcp_f32 v86, v86
  v_rcp_f32 v88, v88
  v_mul_f32 v86, v86, v78
  v_mul_f32 v88, v88, v78
  v_pk_mul_f32 v[148:149], v[148:149], v[86:87] op_sel_hi:[1,0]
  v_pk_mul_f32 v[4:5], v[4:5], v[88:89] op_sel_hi:[1,0]
  v_pk_mul_f32 v[150:151], v[150:151], v[86:87] op_sel_hi:[1,0]
  v_pk_mul_f32 v[6:7], v[6:7], v[88:89] op_sel_hi:[1,0]
  v_pk_mul_f32 v[152:153], v[152:153], v[86:87] op_sel_hi:[1,0]
  v_pk_mul_f32 v[8:9], v[8:9], v[88:89] op_sel_hi:[1,0]
  v_pk_mul_f32 v[154:155], v[154:155], v[86:87] op_sel_hi:[1,0]
  v_pk_mul_f32 v[10:11], v[10:11], v[88:89] op_sel_hi:[1,0]
  v_pk_mul_f32 v[156:157], v[156:157], v[86:87] op_sel_hi:[1,0]
  v_pk_mul_f32 v[12:13], v[12:13], v[88:89] op_sel_hi:[1,0]
  v_pk_mul_f32 v[158:159], v[158:159], v[86:87] op_sel_hi:[1,0]
  v_pk_mul_f32 v[14:15], v[14:15], v[88:89] op_sel_hi:[1,0]
  v_pk_mul_f32 v[160:161], v[160:161], v[86:87] op_sel_hi:[1,0]
  v_pk_mul_f32 v[16:17], v[16:17], v[88:89] op_sel_hi:[1,0]
  v_pk_mul_f32 v[162:163], v[162:163], v[86:87] op_sel_hi:[1,0]
  v_pk_mul_f32 v[18:19], v[18:19], v[88:89] op_sel_hi:[1,0]
  v_pk_mul_f32 v[164:165], v[164:165], v[86:87] op_sel_hi:[1,0]
  v_pk_mul_f32 v[36:37], v[36:37], v[88:89] op_sel_hi:[1,0]
  v_pk_mul_f32 v[166:167], v[166:167], v[86:87] op_sel_hi:[1,0]
  v_pk_mul_f32 v[38:39], v[38:39], v[88:89] op_sel_hi:[1,0]
  v_cvt_pk_bf16_f32 v52, v148, v149
  v_cvt_pk_bf16_f32 v53, v150, v151
  v_cvt_pk_bf16_f32 v54, v152, v153
  v_cvt_pk_bf16_f32 v55, v154, v155
  ds_write_b128 v98, v[52:55] offset:0
  v_cvt_pk_bf16_f32 v56, v156, v157
  v_cvt_pk_bf16_f32 v57, v158, v159
  v_cvt_pk_bf16_f32 v58, v160, v161
  v_cvt_pk_bf16_f32 v59, v162, v163
  ds_write_b128 v98, v[56:59] offset:16
  v_cvt_pk_bf16_f32 v60, v164, v165
  v_cvt_pk_bf16_f32 v61, v166, v167
  v_cvt_pk_bf16_f32 v62, v4, v5
  v_cvt_pk_bf16_f32 v63, v6, v7
  ds_write_b128 v98, v[60:63] offset:32
  v_cvt_pk_bf16_f32 v64, v8, v9
  v_cvt_pk_bf16_f32 v65, v10, v11
  v_cvt_pk_bf16_f32 v66, v12, v13
  v_cvt_pk_bf16_f32 v67, v14, v15
  ds_write_b128 v98, v[64:67] offset:48
  v_cvt_pk_bf16_f32 v68, v16, v17
  v_cvt_pk_bf16_f32 v69, v18, v19
  v_cvt_pk_bf16_f32 v70, v36, v37
  v_cvt_pk_bf16_f32 v71, v38, v39
  ds_write_b128 v98, v[68:71] offset:64
  s_cmp_ge_u32 s28, 3
  s_cbranch_scc1 L_nowd_68
  s_mov_b32 s68, s20
  s_mov_b32 s69, s21
  s_mov_b32 s70, 2211840
  s_mov_b32 s71, 0x20000
  v_min_u32 v3, 159, v0
  v_lshlrev_b32 v3, 3, v3
  s_mul_i32 s48, s6, 20480
  buffer_load_dwordx2 v[104:105], v3, s[68:71], s48 offen
  s_add_u32 s48, s48, 1280
  buffer_load_dwordx2 v[106:107], v3, s[68:71], s48 offen
  s_add_u32 s48, s48, 1280
  buffer_load_dwordx2 v[108:109], v3, s[68:71], s48 offen
  s_add_u32 s48, s48, 1280
  buffer_load_dwordx2 v[110:111], v3, s[68:71], s48 offen
  s_add_u32 s48, s48, 1280
  buffer_load_dwordx2 v[112:113], v3, s[68:71], s48 offen
  s_add_u32 s48, s48, 1280
  buffer_load_dwordx2 v[114:115], v3, s[68:71], s48 offen
  s_add_u32 s48, s48, 1280
  buffer_load_dwordx2 v[116:117], v3, s[68:71], s48 offen
  s_add_u32 s48, s48, 1280
  buffer_load_dwordx2 v[118:119], v3, s[68:71], s48 offen
  s_add_u32 s48, s48, 1280
  buffer_load_dwordx2 v[120:121], v3, s[68:71], s48 offen
  s_add_u32 s48, s48, 1280
  buffer_load_dwordx2 v[122:123], v3, s[68:71], s48 offen
  s_add_u32 s48, s48, 1280
  buffer_load_dwordx2 v[124:125], v3, s[68:71], s48 offen
  s_add_u32 s48, s48, 1280
  buffer_load_dwordx2 v[126:127], v3, s[68:71], s48 offen
  s_add_u32 s48, s48, 1280
  buffer_load_dwordx2 v[128:129], v3, s[68:71], s48 offen
  s_add_u32 s48, s48, 1280
  buffer_load_dwordx2 v[130:131], v3, s[68:71], s48 offen
  s_add_u32 s48, s48, 1280
  buffer_load_dwordx2 v[132:133], v3, s[68:71], s48 offen
  s_add_u32 s48, s48, 1280
  buffer_load_dwordx2 v[134:135], v3, s[68:71], s48 offen
L_nowd_68:
  s_waitcnt lgkmcnt(0)
  s_barrier
  ds_read_b64_tr_b16 v[16:17], v100 offset:0
  ds_read_b64_tr_b16 v[18:19], v100 offset:336
  ds_read_b64_tr_b16 v[20:21], v100 offset:32
  ds_read_b64_tr_b16 v[22:23], v100 offset:368
  ds_read_b64_tr_b16 v[24:25], v100 offset:64
  ds_read_b64_tr_b16 v[26:27], v100 offset:400
  ds_read_b64_tr_b16 v[28:29], v101 offset:0
  ds_read_b64_tr_b16 v[30:31], v101 offset:208
  ds_read_b64_tr_b16 v[32:33], v100 offset:10752
  ds_read_b64_tr_b16 v[34:35], v100 offset:11088
  ds_read_b64_tr_b16 v[36:37], v100 offset:10784
  ds_read_b64_tr_b16 v[38:39], v100 offset:11120
  ds_read_b64_tr_b16 v[40:41], v100 offset:10816
  ds_read_b64_tr_b16 v[42:43], v100 offset:11152
  ds_read_b64_tr_b16 v[44:45], v101 offset:6656
  ds_read_b64_tr_b16 v[46:47], v101 offset:6864
  s_waitcnt lgkmcnt(8)
  v_mfma_f32_16x16x32_bf16 v[4:7], v[16:19], v[28:31], 0
  v_mfma_f32_16x16x32_bf16 v[8:11], v[20:23], v[28:31], 0
  v_mfma_f32_16x16x32_bf16 v[12:15], v[24:27], v[28:31], 0
  ds_read_b64_tr_b16 v[48:49], v100 offset:21504
  ds_read_b64_tr_b16 v[50:51], v100 offset:21840
  ds_read_b64_tr_b16 v[52:53], v100 offset:21536
  ds_read_b64_tr_b16 v[54:55], v100 offset:21872
  ds_read_b64_tr_b16 v[56:57], v100 offset:21568
  ds_read_b64_tr_b16 v[58:59], v100 offset:21904
  ds_read_b64_tr_b16 v[60:61], v101 offset:13312
  ds_read_b64_tr_b16 v[62:63], v101 offset:13520
  s_waitcnt lgkmcnt(8)
  v_mfma_f32_16x16x32_bf16 v[4:7], v[32:35], v[44:47], v[4:7]
  v_mfma_f32_16x16x32_bf16 v[8:11], v[36:39], v[44:47], v[8:11]
  v_mfma_f32_16x16x32_bf16 v[12:15], v[40:43], v[44:47], v[12:15]
  ds_read_b64_tr_b16 v[80:81], v100 offset:32256
  ds_read_b64_tr_b16 v[82:83], v100 offset:32592
  ds_read_b64_tr_b16 v[84:85], v100 offset:32288
  ds_read_b64_tr_b16 v[86:87], v100 offset:32624
  ds_read_b64_tr_b16 v[88:89], v100 offset:32320
  ds_read_b64_tr_b16 v[90:91], v100 offset:32656
  ds_read_b64_tr_b16 v[92:93], v101 offset:19968
  ds_read_b64_tr_b16 v[94:95], v101 offset:20176
  s_waitcnt lgkmcnt(8)
  v_mfma_f32_16x16x32_bf16 v[4:7], v[48:51], v[60:63], v[4:7]
  v_mfma_f32_16x16x32_bf16 v[8:11], v[52:55], v[60:63], v[8:11]
  v_mfma_f32_16x16x32_bf16 v[12:15], v[56:59], v[60:63], v[12:15]
  s_waitcnt lgkmcnt(0)
  v_mfma_f32_16x16x32_bf16 v[4:7], v[80:83], v[92:95], v[4:7]
  v_mfma_f32_16x16x32_bf16 v[8:11], v[84:87], v[92:95], v[8:11]
  v_mfma_f32_16x16x32_bf16 v[12:15], v[88:91], v[92:95], v[12:15]
  s_nop 5
  v_cvt_pk_bf16_f32 v64, v4, v5
  v_cvt_pk_bf16_f32 v65, v6, v7
  v_cvt_pk_bf16_f32 v66, v8, v9
  v_cvt_pk_bf16_f32 v67, v10, v11
  v_cvt_pk_bf16_f32 v68, v12, v13
  v_cvt_pk_bf16_f32 v69, v14, v15
  s_mov_b64 exec, s[72:73]
  buffer_store_dwordx2 v[64:65], v102, s[64:67], 0 offen offset:0 sc1
  buffer_store_dwordx2 v[66:67], v102, s[64:67], 0 offen offset:32 sc1
  s_mov_b64 exec, s[74:75]
  buffer_store_dwordx2 v[68:69], v102, s[64:67], 0 offen offset:64 sc1
  s_mov_b64 exec, -1
  s_waitcnt vmcnt(0)
  s_barrier
  s_mov_b32 s48, 429496730
  v_mul_hi_u32 v3, v0, s48
  v_mul_u32_u24 v4, 10, v3
  v_sub_u32 v4, v0, v4
  s_lshl_b32 s48, s4, 6
  v_min_u32 v3, 63, v3
  v_add_u32 v5, s48, v3
  v_mul_u32_u24 v6, 1280, v5
  v_lshl_add_u32 v6, v4, 4, v6
  s_mul_i32 s48, s5, 160
  buffer_load_dwordx4 v[8:11], v6, s[56:59], s48 offen
  v_lshlrev_b32 v7, 4, v5
  v_add_u32 v7, 4096, v7
  buffer_load_dwordx4 v[12:15], v7, s[64:67], 0 offen sc1
  s_cmp_ge_u32 s6, 108
  s_cbranch_scc1 L_nomoe_c_69
  s_cmp_ge_u32 s28, 4
  s_cbranch_scc1 L_nomoe_c_69
  v_bfe_u32 v16, v1, 4, 1
  v_lshlrev_b32 v16, 5, v16
  v_and_b32 v17, 3, v1
  v_lshl_add_u32 v16, v17, 3, v16
  s_and_b32 s48, s28, 1
  s_lshl_b32 s48, s48, 6
  v_add_u32 v16, s48, v16
  v_bfe_u32 v17, v1, 2, 2
  v_lshrrev_b32 v18, 1, v17
  v_lshlrev_b32 v18, 6, v18
  v_xor_b32 v16, v16, v18
  v_lshrrev_b32 v18, 5, v1
  v_lshl_add_u32 v17, v18, 3, v17
  v_lshl_add_u32 v16, v17, 7, v16
  s_lshr_b32 s48, s28, 1
  s_mul_i32 s48, s48, 20608
  s_add_u32 s48, s48, 102400
  v_add_u32 v16, s48, v16
  s_and_b32 s48, s6, 3
  s_mul_i32 s48, s48, 320
  s_add_u32 s48, s48, 156800
  v_lshlrev_b32 v17, 4, v18
  v_add_u32 v17, s48, v17
  ds_read_b64_tr_b16 v[24:25], v16 offset:0
  ds_read_b64_tr_b16 v[26:27], v16 offset:512
  ds_read_b128 v[64:67], v17 offset:0
  ds_read_b64_tr_b16 v[28:29], v16 offset:2048
  ds_read_b64_tr_b16 v[30:31], v16 offset:2560
  ds_read_b128 v[68:71], v17 offset:32
  ds_read_b64_tr_b16 v[32:33], v16 offset:4096
  ds_read_b64_tr_b16 v[34:35], v16 offset:4608
  ds_read_b128 v[72:75], v17 offset:64
  ds_read_b64_tr_b16 v[36:37], v16 offset:6144
  ds_read_b64_tr_b16 v[38:39], v16 offset:6656
  ds_read_b128 v[76:79], v17 offset:96
  ds_read_b64_tr_b16 v[40:41], v16 offset:8192
  ds_read_b64_tr_b16 v[42:43], v16 offset:8704
  ds_read_b128 v[80:83], v17 offset:128
  ds_read_b64_tr_b16 v[44:45], v16 offset:10240
  ds_read_b64_tr_b16 v[46:47], v16 offset:10752
  ds_read_b128 v[84:87], v17 offset:160
  ds_read_b64_tr_b16 v[48:49], v16 offset:12288
  ds_read_b64_tr_b16 v[50:51], v16 offset:12800
  ds_read_b128 v[88:91], v17 offset:192
  ds_read_b64_tr_b16 v[52:53], v16 offset:14336
  ds_read_b64_tr_b16 v[54:55], v16 offset:14848
  ds_read_b128 v[92:95], v17 offset:224
  ds_read_b64_tr_b16 v[56:57], v16 offset:16384
  ds_read_b64_tr_b16 v[58:59], v16 offset:16896
  ds_read_b128 v[96:99], v17 offset:256
  ds_read_b64_tr_b16 v[60:61], v16 offset:18432
  ds_read_b64_tr_b16 v[62:63], v16 offset:18944
  ds_read_b128 v[100:103], v17 offset:288
  s_waitcnt lgkmcnt(15)
  v_mfma_f32_32x32x16_bf16 v[136:151], v[24:27], v[64:67], 0
  s_waitcnt lgkmcnt(15)
  v_mfma_f32_32x32x16_bf16 v[136:151], v[28:31], v[68:71], v[136:151]
  s_waitcnt lgkmcnt(15)
  v_mfma_f32_32x32x16_bf16 v[136:151], v[32:35], v[72:75], v[136:151]
  s_waitcnt lgkmcnt(15)
  v_mfma_f32_32x32x16_bf16 v[136:151], v[36:39], v[76:79], v[136:151]
  s_waitcnt lgkmcnt(15)
  v_mfma_f32_32x32x16_bf16 v[136:151], v[40:43], v[80:83], v[136:151]
  s_waitcnt lgkmcnt(12)
  v_mfma_f32_32x32x16_bf16 v[136:151], v[44:47], v[84:87], v[136:151]
  s_waitcnt lgkmcnt(9)
  v_mfma_f32_32x32x16_bf16 v[136:151], v[48:51], v[88:91], v[136:151]
  s_waitcnt lgkmcnt(6)
  v_mfma_f32_32x32x16_bf16 v[136:151], v[52:55], v[92:95], v[136:151]
  s_waitcnt lgkmcnt(3)
  v_mfma_f32_32x32x16_bf16 v[136:151], v[56:59], v[96:99], v[136:151]
  s_waitcnt lgkmcnt(0)
  v_mfma_f32_32x32x16_bf16 v[136:151], v[60:63], v[100:103], v[136:151]
  v_lshrrev_b32 v16, 5, v1
  v_lshlrev_b32 v16, 4, v16
  s_lshl_b32 s48, s28, 7
  s_add_u32 s48, s48, 158080
  v_add_u32 v16, s48, v16
  s_mov_b64 s[52:53], exec
  s_mov_b32 exec_lo, 1
  s_mov_b32 exec_hi, 1
  s_nop 3
  ds_write_b128 v16, v[136:139] offset:0
  ds_write_b128 v16, v[140:143] offset:32
  ds_write_b128 v16, v[144:147] offset:64
  ds_write_b128 v16, v[148:151] offset:96
  s_mov_b64 exec, s[52:53]
  s_waitcnt lgkmcnt(0)
  v_and_b32 v16, 31, v1
  v_lshlrev_b32 v17, 2, v16
  v_add_u32 v17, s48, v17
  ds_read_b32 v18, v17
  v_mov_b32 v19, s29
  v_lshlrev_b32 v16, 3, v16
  s_lshl_b32 s48, s6, 10
  s_lshl_b32 s49, s28, 8
  s_add_u32 s48, s48, s49
  s_add_u32 s48, s48, 5767168
  s_mov_b64 s[52:53], exec
  s_mov_b32 exec_hi, 0
  s_waitcnt lgkmcnt(0)
  buffer_store_dwordx2 v[18:19], v16, s[64:67], s48 offen sc1
  s_mov_b64 exec, s[52:53]
  s_cmp_ge_u32 s28, 3
  s_cbranch_scc1 L_nomoe4_70
  v_lshrrev_b32 v16, 4, v1
  v_lshlrev_b32 v16, 10, v16
  v_and_b32 v17, 15, v1
  v_lshl_add_u32 v16, v17, 3, v16
  s_and_b32 s48, s6, 3
  s_lshl_b32 s48, s48, 7
  s_lshr_b32 s49, s6, 2
  s_lshl_b32 s49, s49, 12
  s_add_u32 s48, s48, s49
  s_add_u32 s51, s48, 5767168
  s_waitcnt lgkmcnt(0)
  s_mov_b32 s50, 0
L_yg_again_71:
  buffer_load_dwordx2 v[24:25], v16, s[64:67], s51 offen sc1
  buffer_load_dwordx2 v[26:27], v16, s[64:67], s51 offen offset:512 sc1
  s_waitcnt vmcnt(0)
  v_cmp_ne_u32 vcc, s29, v25
  v_cmp_ne_u32 s[48:49], s29, v27
  s_nop 1
  s_or_b64 vcc, vcc, s[48:49]
  s_cbranch_vccz L_yg_ok_72
  s_add_u32 s50, s50, 1
  s_cmp_gt_u32 s50, 40000
  s_cbranch_scc0 L_yg_again_71
L_yg_ok_72:
  v_mov_b32 v18, v24
  s_nop 1
  v_permlane16_swap_b32 v18, v24
  v_add_f32 v24, v24, v18
  v_mov_b32 v18, v24
  s_nop 1
  v_permlane32_swap_b32 v18, v24
  v_add_f32 v24, v24, v18
  v_mov_b32 v18, v26
  s_nop 1
  v_permlane16_swap_b32 v18, v26
  v_add_f32 v26, v26, v18
  v_mov_b32 v18, v26
  s_nop 1
  v_permlane32_swap_b32 v18, v26
  v_add_f32 v26, v26, v18
  v_cvt_pk_bf16_f32 v19, v24, v26
  v_lshlrev_b32 v17, 16, v19
  v_and_b32 v18, s34, v19
  v_mul_f32 v19, 0xbfb8aa3b, v17
  v_exp_f32 v19, v19
  s_nop 0
  v_add_f32 v19, 1.0, v19
  v_rcp_f32 v19, v19
  s_nop 0
  v_mul_f32 v17, v17, v19
  v_cvt_pk_bf16_f32 v17, v17, v17
  v_lshlrev_b32 v17, 16, v17
  v_mul_f32 v17, v17, v18
  v_cvt_pk_bf16_f32 v17, v17, v17
  v_lshlrev_b32 v17, 16, v17
  v_mov_b32 v18, 156736
  ds_read_b32 v19, v18 offset:4
  s_waitcnt lgkmcnt(0)
  v_and_b32 v19, 0xfffff800, v19
  v_ashrrev_i32 v20, 31, v19
  v_not_b32 v20, v20
  v_or_b32 v20, 0x80000000, v20
  v_xor_b32 v19, v19, v20
  v_mul_f32 v19, 0xbfb8aa3b, v19
  v_exp_f32 v19, v19
  s_nop 0
  v_add_f32 v19, 1.0, v19
  v_rcp_f32 v19, v19
  s_nop 0
  v_mul_f32 v17, v17, v19
  s_lshl_b32 s48, s28, 6
  s_add_u32 s48, s48, 159104
  v_and_b32 v16, 15, v1
  v_lshlrev_b32 v16, 2, v16
  v_add_u32 v16, s48, v16
  ds_write_b32 v16, v17
  s_waitcnt lgkmcnt(0)
  v_mov_b32 v16, s48
  ds_read_b128 v[24:27], v16 offset:0
  ds_read_b128 v[28:31], v16 offset:16
  ds_read_b128 v[32:35], v16 offset:32
  ds_read_b128 v[36:39], v16 offset:48
  v_lshlrev_b32 v64, 16, v104
  v_and_b32 v65, s34, v104
  v_lshlrev_b32 v66, 16, v105
  v_and_b32 v67, s34, v105
  s_waitcnt lgkmcnt(3)
  v_mul_f32 v136, v24, v64
  v_mul_f32 v137, v24, v65
  v_mul_f32 v138, v24, v66
  v_mul_f32 v139, v24, v67
  v_lshlrev_b32 v64, 16, v106
  v_and_b32 v65, s34, v106
  v_lshlrev_b32 v66, 16, v107
  v_and_b32 v67, s34, v107
  v_fmac_f32 v136, v25, v64
  v_fmac_f32 v137, v25, v65
  v_fmac_f32 v138, v25, v66
  v_fmac_f32 v139, v25, v67
  v_lshlrev_b32 v64, 16, v108
  v_and_b32 v65, s34, v108
  v_lshlrev_b32 v66, 16, v109
  v_and_b32 v67, s34, v109
  v_fmac_f32 v136, v26, v64
  v_fmac_f32 v137, v26, v65
  v_fmac_f32 v138, v26, v66
  v_fmac_f32 v139, v26, v67
  v_lshlrev_b32 v64, 16, v110
  v_and_b32 v65, s34, v110
  v_lshlrev_b32 v66, 16, v111
  v_and_b32 v67, s34, v111
  v_fmac_f32 v136, v27, v64
  v_fmac_f32 v137, v27, v65
  v_fmac_f32 v138, v27, v66
  v_fmac_f32 v139, v27, v67
  v_lshlrev_b32 v64, 16, v112
  v_and_b32 v65, s34, v112
  v_lshlrev_b32 v66, 16, v113
  v_and_b32 v67, s34, v113
  s_waitcnt lgkmcnt(2)
  v_fmac_f32 v136, v28, v64
  v_fmac_f32 v137, v28, v65
  v_fmac_f32 v138, v28, v66
  v_fmac_f32 v139, v28, v67
  v_lshlrev_b32 v64, 16, v114
  v_and_b32 v65, s34, v114
  v_lshlrev_b32 v66, 16, v115
  v_and_b32 v67, s34, v115
  v_fmac_f32 v136, v29, v64
  v_fmac_f32 v137, v29, v65
  v_fmac_f32 v138, v29, v66
  v_fmac_f32 v139, v29, v67
  v_lshlrev_b32 v64, 16, v116
  v_and_b32 v65, s34, v116
  v_lshlrev_b32 v66, 16, v117
  v_and_b32 v67, s34, v117
  v_fmac_f32 v136, v30, v64
  v_fmac_f32 v137, v30, v65
  v_fmac_f32 v138, v30, v66
  v_fmac_f32 v139, v30, v67
  v_lshlrev_b32 v64, 16, v118
  v_and_b32 v65, s34, v118
  v_lshlrev_b32 v66, 16, v119
  v_and_b32 v67, s34, v119
  v_fmac_f32 v136, v31, v64
  v_fmac_f32 v137, v31, v65
  v_fmac_f32 v138, v31, v66
  v_fmac_f32 v139, v31, v67
  v_lshlrev_b32 v64, 16, v120
  v_and_b32 v65, s34, v120
  v_lshlrev_b32 v66, 16, v121
  v_and_b32 v67, s34, v121
  s_waitcnt lgkmcnt(1)
  v_fmac_f32 v136, v32, v64
  v_fmac_f32 v137, v32, v65
  v_fmac_f32 v138, v32, v66
  v_fmac_f32 v139, v32, v67
  v_lshlrev_b32 v64, 16, v122
  v_and_b32 v65, s34, v122
  v_lshlrev_b32 v66, 16, v123
  v_and_b32 v67, s34, v123
  v_fmac_f32 v136, v33, v64
  v_fmac_f32 v137, v33, v65
  v_fmac_f32 v138, v33, v66
  v_fmac_f32 v139, v33, v67
  v_lshlrev_b32 v64, 16, v124
  v_and_b32 v65, s34, v124
  v_lshlrev_b32 v66, 16, v125
  v_and_b32 v67, s34, v125
  v_fmac_f32 v136, v34, v64
  v_fmac_f32 v137, v34, v65
  v_fmac_f32 v138, v34, v66
  v_fmac_f32 v139, v34, v67
  v_lshlrev_b32 v64, 16, v126
  v_and_b32 v65, s34, v126
  v_lshlrev_b32 v66, 16, v127
  v_and_b32 v67, s34, v127
  v_fmac_f32 v136, v35, v64
  v_fmac_f32 v137, v35, v65
  v_fmac_f32 v138, v35, v66
  v_fmac_f32 v139, v35, v67
  v_lshlrev_b32 v64, 16, v128
  v_and_b32 v65, s34, v128
  v_lshlrev_b32 v66, 16, v129
  v_and_b32 v67, s34, v129
  s_waitcnt lgkmcnt(0)
  v_fmac_f32 v136, v36, v64
  v_fmac_f32 v137, v36, v65
  v_fmac_f32 v138, v36, v66
  v_fmac_f32 v139, v36, v67
  v_lshlrev_b32 v64, 16, v130
  v_and_b32 v65, s34, v130
  v_lshlrev_b32 v66, 16, v131
  v_and_b32 v67, s34, v131
  v_fmac_f32 v136, v37, v64
  v_fmac_f32 v137, v37, v65
  v_fmac_f32 v138, v37, v66
  v_fmac_f32 v139, v37, v67
  v_lshlrev_b32 v64, 16, v132
  v_and_b32 v65, s34, v132
  v_lshlrev_b32 v66, 16, v133
  v_and_b32 v67, s34, v133
  v_fmac_f32 v136, v38, v64
  v_fmac_f32 v137, v38, v65
  v_fmac_f32 v138, v38, v66
  v_fmac_f32 v139, v38, v67
  v_lshlrev_b32 v64, 16, v134
  v_and_b32 v65, s34, v134
  v_lshlrev_b32 v66, 16, v135
  v_and_b32 v67, s34, v135
  v_fmac_f32 v136, v39, v64
  v_fmac_f32 v137, v39, v65
  v_fmac_f32 v138, v39, v66
  v_fmac_f32 v139, v39, v67
  v_lshlrev_b32 v16, 4, v0
  s_mul_i32 s48, s6, 2560
  s_add_u32 s48, s48, 5242880
  v_cmp_gt_u32 vcc, 160, v0
  s_nop 0
  s_and_saveexec_b64 s[52:53], vcc
  buffer_store_dwordx4 v[136:139], v16, s[64:67], s48 offen sc1
  s_mov_b64 exec, s[52:53]
  s_waitcnt vmcnt(0) lgkmcnt(0)
  v_mov_b32 v16, 163136
  v_mov_b32 v17, 1
  s_mov_b64 s[54:55], exec
  s_mov_b64 exec, 1
  ds_add_rtn_u32 v18, v16, v17
  s_mov_b64 exec, s[54:55]
  s_waitcnt lgkmcnt(0)
  v_readfirstlane_b32 s48, v18
  s_nop 0
  s_cmp_lg_u32 s48, 2
  s_cbranch_scc1 L_noflag3_73
  s_lshl_b32 s48, s6, 2
  s_add_u32 s48, s48, 81920
  v_mov_b32 v16, s29
  v_mov_b32 v17, 0
  s_mov_b64 s[54:55], exec
  s_mov_b64 exec, 1
  buffer_store_dword v16, v17, s[64:67], s48 offen sc1
  s_mov_b64 exec, s[54:55]
L_noflag3_73:
L_nomoe4_70:
  s_waitcnt vmcnt(0) lgkmcnt(0)
L_nomoe_c_69:
  s_waitcnt vmcnt(0) lgkmcnt(0)
  s_barrier
  s_and_b32 s48, s28, 3
  s_lshl_b32 s49, s4, 2
  s_add_u32 s48, s48, s49
  s_mul_i32 s48, s48, 20480
  s_lshr_b32 s49, s28, 2
  s_mul_i32 s50, s49, 10240
  s_add_u32 s48, s48, s50
  s_add_u32 s12, s48, 2097152
  v_lshrrev_b32 v16, 4, v1
  v_bfe_u32 v17, v1, 2, 2
  v_and_b32 v18, 3, v1
  v_lshlrev_b32 v20, 10, v16
  v_lshl_add_u32 v20, v17, 7, v20
  v_lshl_add_u32 v20, v18, 3, v20
  v_lshrrev_b32 v19, 1, v17
  v_lshl_add_u32 v20, v19, 5, v20
  v_and_b32 v19, 1, v16
  v_lshl_add_u32 v20, v19, 6, v20
  s_mul_i32 s50, s49, 40960
  s_add_u32 s50, s50, 0
  v_xor_b32 v21, 32, v20
  v_xor_b32 v22, 64, v20
  v_xor_b32 v23, 96, v20
  v_add_u32 v20, s50, v20
  v_add_u32 v21, s50, v21
  v_add_u32 v22, s50, v22
  v_add_u32 v23, s50, v23
  v_lshlrev_b32 v6, 8, v16
  v_lshl_add_u32 v6, v17, 5, v6
  v_lshl_add_u32 v6, v18, 3, v6
  s_mul_i32 s50, s49, 10240
  s_add_u32 s50, s50, 81920
  v_add_u32 v6, s50, v6
  v_lshlrev_b32 v19, 7, v19
  v_xor_b32 v7, 128, v19
  v_add_u32 v7, v7, v6
  v_add_u32 v6, v19, v6
  ds_read_b64_tr_b16 v[24:25], v20 offset:0
  ds_read_b64_tr_b16 v[26:27], v20 offset:512
  ds_read_b64_tr_b16 v[28:29], v21 offset:0
  ds_read_b64_tr_b16 v[30:31], v21 offset:512
  ds_read_b64_tr_b16 v[32:33], v22 offset:0
  ds_read_b64_tr_b16 v[34:35], v22 offset:512
  ds_read_b64_tr_b16 v[36:37], v23 offset:0
  ds_read_b64_tr_b16 v[38:39], v23 offset:512
  ds_read_b64_tr_b16 v[40:41], v6 offset:0
  ds_read_b64_tr_b16 v[42:43], v7 offset:0
  ds_read_b64_tr_b16 v[44:45], v20 offset:4096
  ds_read_b64_tr_b16 v[46:47], v20 offset:4608
  ds_read_b64_tr_b16 v[48:49], v21 offset:4096
  ds_read_b64_tr_b16 v[50:51], v21 offset:4608
  ds_read_b64_tr_b16 v[52:53], v22 offset:4096
  ds_read_b64_tr_b16 v[54:55], v22 offset:4608
  ds_read_b64_tr_b16 v[56:57], v23 offset:4096
  ds_read_b64_tr_b16 v[58:59], v23 offset:4608
  ds_read_b64_tr_b16 v[60:61], v6 offset:1024
  ds_read_b64_tr_b16 v[62:63], v7 offset:1024
  ds_read_b64_tr_b16 v[64:65], v20 offset:8192
  ds_read_b64_tr_b16 v[66:67], v20 offset:8704
  ds_read_b64_tr_b16 v[68:69], v21 offset:8192
  ds_read_b64_tr_b16 v[70:71], v21 offset:8704
  ds_read_b64_tr_b16 v[72:73], v22 offset:8192
  ds_read_b64_tr_b16 v[74:75], v22 offset:8704
  ds_read_b64_tr_b16 v[76:77], v23 offset:8192
  ds_read_b64_tr_b16 v[78:79], v23 offset:8704
  ds_read_b64_tr_b16 v[80:81], v6 offset:2048
  ds_read_b64_tr_b16 v[82:83], v7 offset:2048
  v_lshlrev_b32 v16, 4, v1
  v_mov_b32 v84, 156736
  ds_read_b32 v84, v84
  s_waitcnt lgkmcnt(0)
  v_readfirstlane_b32 s13, v84
  s_barrier
  buffer_load_dwordx4 v[84:87], v16, s[64:67], s12 offen sc1
  s_add_u32 s12, s12, 1024
  buffer_load_dwordx4 v[88:91], v16, s[64:67], s12 offen sc1
  s_add_u32 s12, s12, 1024
  buffer_load_dwordx4 v[92:95], v16, s[64:67], s12 offen sc1
  s_add_u32 s12, s12, 1024
  buffer_load_dwordx4 v[96:99], v16, s[64:67], s12 offen sc1
  s_add_u32 s12, s12, 1024
  buffer_load_dwordx4 v[100:103], v16, s[64:67], s12 offen sc1
  s_add_u32 s12, s12, 1024
  buffer_load_dwordx4 v[104:107], v16, s[64:67], s12 offen sc1
  s_add_u32 s12, s12, 1024
  buffer_load_dwordx4 v[108:111], v16, s[64:67], s12 offen sc1
  s_add_u32 s12, s12, 1024
  buffer_load_dwordx4 v[112:115], v16, s[64:67], s12 offen sc1
  s_add_u32 s12, s12, 1024
  buffer_load_dwordx4 v[116:119], v16, s[64:67], s12 offen sc1
  s_add_u32 s12, s12, 1024
  buffer_load_dwordx4 v[120:123], v16, s[64:67], s12 offen sc1
  s_waitcnt vmcnt(9)
  v_mfma_f32_16x16x32_bf16 v[124:127], v[24:27], v[84:87], 0
  v_mfma_f32_16x16x32_bf16 v[128:131], v[28:31], v[84:87], 0
  v_mfma_f32_16x16x32_bf16 v[132:135], v[32:35], v[84:87], 0
  v_mfma_f32_16x16x32_bf16 v[136:139], v[36:39], v[84:87], 0
  v_mfma_f32_16x16x32_bf16 v[140:143], v[40:43], v[84:87], 0
  ds_read_b64_tr_b16 v[24:25], v20 offset:12288
  ds_read_b64_tr_b16 v[26:27], v20 offset:12800
  ds_read_b64_tr_b16 v[28:29], v21 offset:12288
  ds_read_b64_tr_b16 v[30:31], v21 offset:12800
  ds_read_b64_tr_b16 v[32:33], v22 offset:12288
  ds_read_b64_tr_b16 v[34:35], v22 offset:12800
  ds_read_b64_tr_b16 v[36:37], v23 offset:12288
  ds_read_b64_tr_b16 v[38:39], v23 offset:12800
  ds_read_b64_tr_b16 v[40:41], v6 offset:3072
  ds_read_b64_tr_b16 v[42:43], v7 offset:3072
  s_waitcnt vmcnt(8)
  v_mfma_f32_16x16x32_bf16 v[124:127], v[44:47], v[88:91], v[124:127]
  v_mfma_f32_16x16x32_bf16 v[128:131], v[48:51], v[88:91], v[128:131]
  v_mfma_f32_16x16x32_bf16 v[132:135], v[52:55], v[88:91], v[132:135]
  v_mfma_f32_16x16x32_bf16 v[136:139], v[56:59], v[88:91], v[136:139]
  v_mfma_f32_16x16x32_bf16 v[140:143], v[60:63], v[88:91], v[140:143]
  ds_read_b64_tr_b16 v[44:45], v20 offset:16384
  ds_read_b64_tr_b16 v[46:47], v20 offset:16896
  ds_read_b64_tr_b16 v[48:49], v21 offset:16384
  ds_read_b64_tr_b16 v[50:51], v21 offset:16896
  ds_read_b64_tr_b16 v[52:53], v22 offset:16384
  ds_read_b64_tr_b16 v[54:55], v22 offset:16896
  ds_read_b64_tr_b16 v[56:57], v23 offset:16384
  ds_read_b64_tr_b16 v[58:59], v23 offset:16896
  ds_read_b64_tr_b16 v[60:61], v6 offset:4096
  ds_read_b64_tr_b16 v[62:63], v7 offset:4096
  s_waitcnt vmcnt(7)
  v_mfma_f32_16x16x32_bf16 v[124:127], v[64:67], v[92:95], v[124:127]
  v_mfma_f32_16x16x32_bf16 v[128:131], v[68:71], v[92:95], v[128:131]
  v_mfma_f32_16x16x32_bf16 v[132:135], v[72:75], v[92:95], v[132:135]
  v_mfma_f32_16x16x32_bf16 v[136:139], v[76:79], v[92:95], v[136:139]
  v_mfma_f32_16x16x32_bf16 v[140:143], v[80:83], v[92:95], v[140:143]
  ds_read_b64_tr_b16 v[64:65], v20 offset:20480
  ds_read_b64_tr_b16 v[66:67], v20 offset:20992
  ds_read_b64_tr_b16 v[68:69], v21 offset:20480
  ds_read_b64_tr_b16 v[70:71], v21 offset:20992
  ds_read_b64_tr_b16 v[72:73], v22 offset:20480
  ds_read_b64_tr_b16 v[74:75], v22 offset:20992
  ds_read_b64_tr_b16 v[76:77], v23 offset:20480
  ds_read_b64_tr_b16 v[78:79], v23 offset:20992
  ds_read_b64_tr_b16 v[80:81], v6 offset:5120
  ds_read_b64_tr_b16 v[82:83], v7 offset:5120
  s_waitcnt vmcnt(6) lgkmcnt(15)
  v_mfma_f32_16x16x32_bf16 v[124:127], v[24:27], v[96:99], v[124:127]
  s_waitcnt lgkmcnt(15)
  v_mfma_f32_16x16x32_bf16 v[128:131], v[28:31], v[96:99], v[128:131]
  s_waitcnt lgkmcnt(15)
  v_mfma_f32_16x16x32_bf16 v[132:135], v[32:35], v[96:99], v[132:135]
  s_waitcnt lgkmcnt(15)
  v_mfma_f32_16x16x32_bf16 v[136:139], v[36:39], v[96:99], v[136:139]
  s_waitcnt lgkmcnt(15)
  v_mfma_f32_16x16x32_bf16 v[140:143], v[40:43], v[96:99], v[140:143]
  ds_read_b64_tr_b16 v[24:25], v20 offset:24576
  ds_read_b64_tr_b16 v[26:27], v20 offset:25088
  ds_read_b64_tr_b16 v[28:29], v21 offset:24576
  ds_read_b64_tr_b16 v[30:31], v21 offset:25088
  ds_read_b64_tr_b16 v[32:33], v22 offset:24576
  ds_read_b64_tr_b16 v[34:35], v22 offset:25088
  ds_read_b64_tr_b16 v[36:37], v23 offset:24576
  ds_read_b64_tr_b16 v[38:39], v23 offset:25088
  ds_read_b64_tr_b16 v[40:41], v6 offset:6144
  ds_read_b64_tr_b16 v[42:43], v7 offset:6144
  s_waitcnt vmcnt(5) lgkmcnt(15)
  v_mfma_f32_16x16x32_bf16 v[124:127], v[44:47], v[100:103], v[124:127]
  s_waitcnt lgkmcnt(15)
  v_mfma_f32_16x16x32_bf16 v[128:131], v[48:51], v[100:103], v[128:131]
  s_waitcnt lgkmcnt(15)
  v_mfma_f32_16x16x32_bf16 v[132:135], v[52:55], v[100:103], v[132:135]
  s_waitcnt lgkmcnt(15)
  v_mfma_f32_16x16x32_bf16 v[136:139], v[56:59], v[100:103], v[136:139]
  s_waitcnt lgkmcnt(15)
  v_mfma_f32_16x16x32_bf16 v[140:143], v[60:63], v[100:103], v[140:143]
  ds_read_b64_tr_b16 v[44:45], v20 offset:28672
  ds_read_b64_tr_b16 v[46:47], v20 offset:29184
  ds_read_b64_tr_b16 v[48:49], v21 offset:28672
  ds_read_b64_tr_b16 v[50:51], v21 offset:29184
  ds_read_b64_tr_b16 v[52:53], v22 offset:28672
  ds_read_b64_tr_b16 v[54:55], v22 offset:29184
  ds_read_b64_tr_b16 v[56:57], v23 offset:28672
  ds_read_b64_tr_b16 v[58:59], v23 offset:29184
  ds_read_b64_tr_b16 v[60:61], v6 offset:7168
  ds_read_b64_tr_b16 v[62:63], v7 offset:7168
  s_waitcnt vmcnt(4) lgkmcnt(15)
  v_mfma_f32_16x16x32_bf16 v[124:127], v[64:67], v[104:107], v[124:127]
  s_waitcnt lgkmcnt(15)
  v_mfma_f32_16x16x32_bf16 v[128:131], v[68:71], v[104:107], v[128:131]
  s_waitcnt lgkmcnt(15)
  v_mfma_f32_16x16x32_bf16 v[132:135], v[72:75], v[104:107], v[132:135]
  s_waitcnt lgkmcnt(15)
  v_mfma_f32_16x16x32_bf16 v[136:139], v[76:79], v[104:107], v[136:139]
  s_waitcnt lgkmcnt(15)
  v_mfma_f32_16x16x32_bf16 v[140:143], v[80:83], v[104:107], v[140:143]
  ds_read_b64_tr_b16 v[64:65], v20 offset:32768
  ds_read_b64_tr_b16 v[66:67], v20 offset:33280
  ds_read_b64_tr_b16 v[68:69], v21 offset:32768
  ds_read_b64_tr_b16 v[70:71], v21 offset:33280
  ds_read_b64_tr_b16 v[72:73], v22 offset:32768
  ds_read_b64_tr_b16 v[74:75], v22 offset:33280
  ds_read_b64_tr_b16 v[76:77], v23 offset:32768
  ds_read_b64_tr_b16 v[78:79], v23 offset:33280
  ds_read_b64_tr_b16 v[80:81], v6 offset:8192
  ds_read_b64_tr_b16 v[82:83], v7 offset:8192
  s_waitcnt vmcnt(3) lgkmcnt(15)
  v_mfma_f32_16x16x32_bf16 v[124:127], v[24:27], v[108:111], v[124:127]
  s_waitcnt lgkmcnt(15)
  v_mfma_f32_16x16x32_bf16 v[128:131], v[28:31], v[108:111], v[128:131]
  s_waitcnt lgkmcnt(15)
  v_mfma_f32_16x16x32_bf16 v[132:135], v[32:35], v[108:111], v[132:135]
  s_waitcnt lgkmcnt(15)
  v_mfma_f32_16x16x32_bf16 v[136:139], v[36:39], v[108:111], v[136:139]
  s_waitcnt lgkmcnt(15)
  v_mfma_f32_16x16x32_bf16 v[140:143], v[40:43], v[108:111], v[140:143]
  ds_read_b64_tr_b16 v[24:25], v20 offset:36864
  ds_read_b64_tr_b16 v[26:27], v20 offset:37376
  ds_read_b64_tr_b16 v[28:29], v21 offset:36864
  ds_read_b64_tr_b16 v[30:31], v21 offset:37376
  ds_read_b64_tr_b16 v[32:33], v22 offset:36864
  ds_read_b64_tr_b16 v[34:35], v22 offset:37376
  ds_read_b64_tr_b16 v[36:37], v23 offset:36864
  ds_read_b64_tr_b16 v[38:39], v23 offset:37376
  ds_read_b64_tr_b16 v[40:41], v6 offset:9216
  ds_read_b64_tr_b16 v[42:43], v7 offset:9216
  s_waitcnt vmcnt(2) lgkmcnt(15)
  v_mfma_f32_16x16x32_bf16 v[124:127], v[44:47], v[112:115], v[124:127]
  s_waitcnt lgkmcnt(15)
  v_mfma_f32_16x16x32_bf16 v[128:131], v[48:51], v[112:115], v[128:131]
  s_waitcnt lgkmcnt(15)
  v_mfma_f32_16x16x32_bf16 v[132:135], v[52:55], v[112:115], v[132:135]
  s_waitcnt lgkmcnt(15)
  v_mfma_f32_16x16x32_bf16 v[136:139], v[56:59], v[112:115], v[136:139]
  s_waitcnt lgkmcnt(15)
  v_mfma_f32_16x16x32_bf16 v[140:143], v[60:63], v[112:115], v[140:143]
  s_waitcnt vmcnt(1) lgkmcnt(15)
  v_mfma_f32_16x16x32_bf16 v[124:127], v[64:67], v[116:119], v[124:127]
  s_waitcnt lgkmcnt(15)
  v_mfma_f32_16x16x32_bf16 v[128:131], v[68:71], v[116:119], v[128:131]
  s_waitcnt lgkmcnt(14)
  v_mfma_f32_16x16x32_bf16 v[132:135], v[72:75], v[116:119], v[132:135]
  s_waitcnt lgkmcnt(12)
  v_mfma_f32_16x16x32_bf16 v[136:139], v[76:79], v[116:119], v[136:139]
  s_waitcnt lgkmcnt(10)
  v_mfma_f32_16x16x32_bf16 v[140:143], v[80:83], v[116:119], v[140:143]
  s_waitcnt vmcnt(0) lgkmcnt(8)
  v_mfma_f32_16x16x32_bf16 v[124:127], v[24:27], v[120:123], v[124:127]
  s_waitcnt lgkmcnt(6)
  v_mfma_f32_16x16x32_bf16 v[128:131], v[28:31], v[120:123], v[128:131]
  s_waitcnt lgkmcnt(4)
  v_mfma_f32_16x16x32_bf16 v[132:135], v[32:35], v[120:123], v[132:135]
  s_waitcnt lgkmcnt(2)
  v_mfma_f32_16x16x32_bf16 v[136:139], v[36:39], v[120:123], v[136:139]
  s_waitcnt lgkmcnt(0)
  v_mfma_f32_16x16x32_bf16 v[140:143], v[40:43], v[120:123], v[140:143]
  s_and_b32 s48, s28, 3
  s_lshl_b32 s48, s48, 4
  v_and_b32 v16, 15, v1
  v_add_u32 v16, s48, v16
  v_mul_u32_u24 v16, 336, v16
  v_lshrrev_b32 v17, 4, v1
  v_lshl_add_u32 v16, v17, 4, v16
  s_lshr_b32 s48, s28, 2
  s_mul_i32 s48, s48, 21504
  s_add_u32 s48, s48, 102400
  v_add_u32 v16, s48, v16
  ds_write_b128 v16, v[124:127] offset:0
  ds_write_b128 v16, v[128:131] offset:64
  ds_write_b128 v16, v[132:135] offset:128
  ds_write_b128 v16, v[136:139] offset:192
  ds_write_b128 v16, v[140:143] offset:256
  s_waitcnt lgkmcnt(0)
  s_barrier
  v_cmp_gt_u32 vcc, 640, v0
  s_nop 0
  s_and_saveexec_b64 s[52:53], vcc
  s_cbranch_execz L_noitem_74
  v_mul_u32_u24 v16, 336, v3
  v_lshl_add_u32 v16, v4, 5, v16
  v_add_u32 v16, 102400, v16
  ds_read_b128 v[20:23], v16
  ds_read_b128 v[24:27], v16 offset:16
  ds_read_b128 v[28:31], v16 offset:21504
  ds_read_b128 v[32:35], v16 offset:21520
  s_waitcnt vmcnt(0) lgkmcnt(0)
  s_mov_b32 s50, 0
L_ist_again_75:
  v_cmp_ne_u32 vcc, s29, v13
  v_cmp_ne_u32 s[48:49], s29, v15
  s_nop 1
  s_or_b64 vcc, vcc, s[48:49]
  s_cbranch_vccz L_ist_ok_76
  s_add_u32 s50, s50, 1
  s_cmp_gt_u32 s50, 40000
  s_cbranch_scc1 L_ist_ok_76
  v_lshlrev_b32 v17, 4, v5
  v_add_u32 v17, 4096, v17
  buffer_load_dwordx4 v[12:15], v17, s[64:67], 0 offen sc1
  s_waitcnt vmcnt(0)
  s_branch L_ist_again_75
L_ist_ok_76:
  v_pk_add_f32 v[20:21], v[20:21], v[28:29]
  v_pk_add_f32 v[22:23], v[22:23], v[30:31]
  v_pk_add_f32 v[24:25], v[24:25], v[32:33]
  v_pk_add_f32 v[26:27], v[26:27], v[34:35]
  v_cmp_eq_u32 vcc, s13, v5
  s_nop 0
  s_and_saveexec_b64 s[48:49], vcc
  s_cbranch_execz L_noy_77
  v_lshlrev_b32 v17, 5, v4
  v_add_u32 v17, 159296, v17
  ds_read_b128 v[28:31], v17 offset:0
  ds_read_b128 v[32:35], v17 offset:16
  s_waitcnt lgkmcnt(1)
  v_add_f32 v20, v20, v28
  v_add_f32 v21, v21, v29
  v_add_f32 v22, v22, v30
  v_add_f32 v23, v23, v31
  s_waitcnt lgkmcnt(0)
  v_add_f32 v24, v24, v32
  v_add_f32 v25, v25, v33
  v_add_f32 v26, v26, v34
  v_add_f32 v27, v27, v35
  ds_read_b128 v[28:31], v17 offset:320
  ds_read_b128 v[32:35], v17 offset:336
  s_waitcnt lgkmcnt(1)
  v_add_f32 v20, v20, v28
  v_add_f32 v21, v21, v29
  v_add_f32 v22, v22, v30
  v_add_f32 v23, v23, v31
  s_waitcnt lgkmcnt(0)
  v_add_f32 v24, v24, v32
  v_add_f32 v25, v25, v33
  v_add_f32 v26, v26, v34
  v_add_f32 v27, v27, v35
  ds_read_b128 v[28:31], v17 offset:640
  ds_read_b128 v[32:35], v17 offset:656
  s_waitcnt lgkmcnt(1)
  v_add_f32 v20, v20, v28
  v_add_f32 v21, v21, v29
  v_add_f32 v22, v22, v30
  v_add_f32 v23, v23, v31
  s_waitcnt lgkmcnt(0)
  v_add_f32 v24, v24, v32
  v_add_f32 v25, v25, v33
  v_add_f32 v26, v26, v34
  v_add_f32 v27, v27, v35
  ds_read_b128 v[28:31], v17 offset:960
  ds_read_b128 v[32:35], v17 offset:976
  s_waitcnt lgkmcnt(1)
  v_add_f32 v20, v20, v28
  v_add_f32 v21, v21, v29
  v_add_f32 v22, v22, v30
  v_add_f32 v23, v23, v31
  s_waitcnt lgkmcnt(0)
  v_add_f32 v24, v24, v32
  v_add_f32 v25, v25, v33
  v_add_f32 v26, v26, v34
  v_add_f32 v27, v27, v35
  ds_read_b128 v[28:31], v17 offset:1280
  ds_read_b128 v[32:35], v17 offset:1296
  s_waitcnt lgkmcnt(1)
  v_add_f32 v20, v20, v28
  v_add_f32 v21, v21, v29
  v_add_f32 v22, v22, v30
  v_add_f32 v23, v23, v31
  s_waitcnt lgkmcnt(0)
  v_add_f32 v24, v24, v32
  v_add_f32 v25, v25, v33
  v_add_f32 v26, v26, v34
  v_add_f32 v27, v27, v35
  ds_read_b128 v[28:31], v17 offset:1600
  ds_read_b128 v[32:35], v17 offset:1616
  s_waitcnt lgkmcnt(1)
  v_add_f32 v20, v20, v28
  v_add_f32 v21, v21, v29
  v_add_f32 v22, v22, v30
  v_add_f32 v23, v23, v31
  s_waitcnt lgkmcnt(0)
  v_add_f32 v24, v24, v32
  v_add_f32 v25, v25, v33
  v_add_f32 v26, v26, v34
  v_add_f32 v27, v27, v35
  ds_read_b128 v[28:31], v17 offset:1920
  ds_read_b128 v[32:35], v17 offset:1936
  s_waitcnt lgkmcnt(1)
  v_add_f32 v20, v20, v28
  v_add_f32 v21, v21, v29
  v_add_f32 v22, v22, v30
  v_add_f32 v23, v23, v31
  s_waitcnt lgkmcnt(0)
  v_add_f32 v24, v24, v32
  v_add_f32 v25, v25, v33
  v_add_f32 v26, v26, v34
  v_add_f32 v27, v27, v35
  ds_read_b128 v[28:31], v17 offset:2240
  ds_read_b128 v[32:35], v17 offset:2256
  s_waitcnt lgkmcnt(1)
  v_add_f32 v20, v20, v28
  v_add_f32 v21, v21, v29
  v_add_f32 v22, v22, v30
  v_add_f32 v23, v23, v31
  s_waitcnt lgkmcnt(0)
  v_add_f32 v24, v24, v32
  v_add_f32 v25, v25, v33
  v_add_f32 v26, v26, v34
  v_add_f32 v27, v27, v35
  ds_read_b128 v[28:31], v17 offset:2560
  ds_read_b128 v[32:35], v17 offset:2576
  s_waitcnt lgkmcnt(1)
  v_add_f32 v20, v20, v28
  v_add_f32 v21, v21, v29
  v_add_f32 v22, v22, v30
  v_add_f32 v23, v23, v31
  s_waitcnt lgkmcnt(0)
  v_add_f32 v24, v24, v32
  v_add_f32 v25, v25, v33
  v_add_f32 v26, v26, v34
  v_add_f32 v27, v27, v35
  ds_read_b128 v[28:31], v17 offset:2880
  ds_read_b128 v[32:35], v17 offset:2896
  s_waitcnt lgkmcnt(1)
  v_add_f32 v20, v20, v28
  v_add_f32 v21, v21, v29
  v_add_f32 v22, v22, v30
  v_add_f32 v23, v23, v31
  s_waitcnt lgkmcnt(0)
  v_add_f32 v24, v24, v32
  v_add_f32 v25, v25, v33
  v_add_f32 v26, v26, v34
  v_add_f32 v27, v27, v35
  ds_read_b128 v[28:31], v17 offset:3200
  ds_read_b128 v[32:35], v17 offset:3216
  s_waitcnt lgkmcnt(1)
  v_add_f32 v20, v20, v28
  v_add_f32 v21, v21, v29
  v_add_f32 v22, v22, v30
  v_add_f32 v23, v23, v31
  s_waitcnt lgkmcnt(0)
  v_add_f32 v24, v24, v32
  v_add_f32 v25, v25, v33
  v_add_f32 v26, v26, v34
  v_add_f32 v27, v27, v35
  ds_read_b128 v[28:31], v17 offset:3520
  ds_read_b128 v[32:35], v17 offset:3536
  s_waitcnt lgkmcnt(1)
  v_add_f32 v20, v20, v28
  v_add_f32 v21, v21, v29
  v_add_f32 v22, v22, v30
  v_add_f32 v23, v23, v31
  s_waitcnt lgkmcnt(0)
  v_add_f32 v24, v24, v32
  v_add_f32 v25, v25, v33
  v_add_f32 v26, v26, v34
  v_add_f32 v27, v27, v35
L_noy_77:
  s_mov_b64 exec, s[48:49]
  s_waitcnt vmcnt(0) lgkmcnt(0)
  v_add_f32 v18, 1.0, v14
  v_mul_f32 v6, v12, v14
  v_lshlrev_b32 v28, 16, v8
  v_and_b32 v29, s34, v8
  v_lshlrev_b32 v30, 16, v9
  v_and_b32 v31, s34, v9
  v_lshlrev_b32 v32, 16, v10
  v_and_b32 v33, s34, v10
  v_lshlrev_b32 v34, 16, v11
  v_and_b32 v35, s34, v11
  v_pk_fma_f32 v[28:29], v[28:29], v[18:19], v[6:7] op_sel_hi:[1,0,0] neg_lo:[0,0,1] neg_hi:[0,0,1]
  v_pk_fma_f32 v[30:31], v[30:31], v[18:19], v[6:7] op_sel_hi:[1,0,0] neg_lo:[0,0,1] neg_hi:[0,0,1]
  v_pk_fma_f32 v[32:33], v[32:33], v[18:19], v[6:7] op_sel_hi:[1,0,0] neg_lo:[0,0,1] neg_hi:[0,0,1]
  v_pk_fma_f32 v[34:35], v[34:35], v[18:19], v[6:7] op_sel_hi:[1,0,0] neg_lo:[0,0,1] neg_hi:[0,0,1]
  v_pk_add_f32 v[20:21], v[20:21], v[28:29]
  v_pk_add_f32 v[22:23], v[22:23], v[30:31]
  v_pk_add_f32 v[24:25], v[24:25], v[32:33]
  v_pk_add_f32 v[26:27], v[26:27], v[34:35]
  v_cvt_pk_bf16_f32 v36, v20, v21
  v_cvt_pk_bf16_f32 v37, v22, v23
  v_cvt_pk_bf16_f32 v38, v24, v25
  v_cvt_pk_bf16_f32 v39, v26, v27
  s_mov_b32 s68, s22
  s_mov_b32 s69, s23
  s_mov_b32 s70, 2621440
  s_mov_b32 s71, 0x20000
  v_mul_u32_u24 v16, 1280, v5
  v_lshl_add_u32 v16, v4, 4, v16
  s_mul_i32 s48, s5, 160
  buffer_store_dwordx4 v[36:39], v16, s[68:71], s48 offen
L_noitem_74:
  s_mov_b64 exec, s[52:53]
  s_waitcnt vmcnt(0) lgkmcnt(0)
  s_branch L_end
L_help_KV:
  s_setprio 3
  s_sub_u32 s7, s28, 8
  v_mov_b32 v12, 0
  v_mov_b32 v13, 0
  s_mov_b32 s40, 0
  s_mov_b32 s24, 0
  s_and_b32 s48, s36, 3
  s_mul_i32 s48, s48, 3
  s_add_u32 s48, s48, s37
  s_mul_hi_u32 s49, s48, 429496730
  s_mul_i32 s49, s49, 10
  s_sub_u32 s39, s48, s49
  s_mov_b32 s45, s39
  v_lshrrev_b32 v24, 3, v1
  v_add_u32 v24, s35, v24
  v_mul_u32_u24 v24, 1280, v24
  v_lshrrev_b32 v25, 4, v1
  v_xor_b32 v25, v25, v1
  v_and_b32 v25, 7, v25
  v_lshl_add_u32 v28, v25, 4, v24
  v_xor_b32 v25, 4, v25
  v_lshl_add_u32 v29, v25, 4, v24
  s_mul_i32 s25, s7, 40960
  s_mul_i32 s43, s39, 245760
  s_add_u32 s43, s43, s24
  s_lshl_b32 s44, s39, 7
  s_add_u32 s44, s44, s25
  s_mul_i32 s12, s7, 4096
  s_add_u32 s12, s12, s40
  s_mul_i32 s13, s7, 5120
  s_add_u32 s13, s13, s40
  s_add_u32 m0, s12, 20480
  s_nop 0
  buffer_load_dwordx4 v28, s[56:59], s44 offen lds
  s_add_u32 s48, s44, 10240
  s_add_u32 m0, s12, 21504
  s_nop 0
  buffer_load_dwordx4 v29, s[56:59], s48 offen lds
  s_add_u32 s48, s44, 20480
  s_add_u32 m0, s12, 22528
  s_nop 0
  buffer_load_dwordx4 v28, s[56:59], s48 offen lds
  s_add_u32 s48, s44, 30720
  s_add_u32 m0, s12, 23552
  s_nop 0
  buffer_load_dwordx4 v29, s[56:59], s48 offen lds
  s_mov_b32 s48, 214748365
  v_mul_hi_u32 v30, v1, s48
  v_mul_u32_u24 v31, 20, v30
  v_sub_u32 v31, v1, v31
  v_cmp_le_u32 vcc, 10, v31
  v_subrev_u32 v32, 10, v31
  s_nop 0
  v_cndmask_b32 v32, v31, v32, vcc
  v_cndmask_b32 v33, 0, 5, vcc
  v_and_b32 v34, 3, v32
  v_lshrrev_b32 v35, 1, v34
  v_add_u32 v34, v34, v35
  v_cmp_gt_u32 vcc, 8, v32
  s_nop 1
  v_cndmask_b32 v34, 2, v34, vcc
  v_add_u32 v33, v33, v34
  v_lshrrev_b32 v34, 2, v32
  v_and_b32 v35, 1, v32
  v_cndmask_b32 v34, v35, v34, vcc
  v_mul_u32_u24 v34, 80, v34
  v_add_u32 v33, v33, v34
  v_lshlrev_b32 v33, 4, v33
  v_mul_u32_u24 v34, 3840, v30
  v_add_u32 v36, v33, v34
  v_add_u32 v31, 4, v31
  v_cmp_le_u32 vcc, 20, v31
  v_subrev_u32 v32, 20, v31
  s_nop 0
  v_cndmask_b32 v31, v31, v32, vcc
  v_addc_co_u32 v30, vcc, 3, v30, vcc
  v_cmp_le_u32 vcc, 10, v31
  v_subrev_u32 v32, 10, v31
  s_nop 0
  v_cndmask_b32 v32, v31, v32, vcc
  v_cndmask_b32 v33, 0, 5, vcc
  v_and_b32 v34, 3, v32
  v_lshrrev_b32 v35, 1, v34
  v_add_u32 v34, v34, v35
  v_cmp_gt_u32 vcc, 8, v32
  s_nop 1
  v_cndmask_b32 v34, 2, v34, vcc
  v_add_u32 v33, v33, v34
  v_lshrrev_b32 v34, 2, v32
  v_and_b32 v35, 1, v32
  v_cndmask_b32 v34, v35, v34, vcc
  v_mul_u32_u24 v34, 80, v34
  v_add_u32 v33, v33, v34
  v_lshlrev_b32 v33, 4, v33
  v_mul_u32_u24 v34, 3840, v30
  v_add_u32 v37, v33, v34
  v_add_u32 v31, 4, v31
  v_cmp_le_u32 vcc, 20, v31
  v_subrev_u32 v32, 20, v31
  s_nop 0
  v_cndmask_b32 v31, v31, v32, vcc
  v_addc_co_u32 v30, vcc, 3, v30, vcc
  v_cmp_le_u32 vcc, 10, v31
  v_subrev_u32 v32, 10, v31
  s_nop 0
  v_cndmask_b32 v32, v31, v32, vcc
  v_cndmask_b32 v33, 0, 5, vcc
  v_and_b32 v34, 3, v32
  v_lshrrev_b32 v35, 1, v34
  v_add_u32 v34, v34, v35
  v_cmp_gt_u32 vcc, 8, v32
  s_nop 1
  v_cndmask_b32 v34, 2, v34, vcc
  v_add_u32 v33, v33, v34
  v_lshrrev_b32 v34, 2, v32
  v_and_b32 v35, 1, v32
  v_cndmask_b32 v34, v35, v34, vcc
  v_mul_u32_u24 v34, 80, v34
  v_add_u32 v33, v33, v34
  v_lshlrev_b32 v33, 4, v33
  v_mul_u32_u24 v34, 3840, v30
  v_add_u32 v38, v33, v34
  v_add_u32 v31, 4, v31
  v_cmp_le_u32 vcc, 20, v31
  v_subrev_u32 v32, 20, v31
  s_nop 0
  v_cndmask_b32 v31, v31, v32, vcc
  v_addc_co_u32 v30, vcc, 3, v30, vcc
  v_cmp_le_u32 vcc, 10, v31
  v_subrev_u32 v32, 10, v31
  s_nop 0
  v_cndmask_b32 v32, v31, v32, vcc
  v_cndmask_b32 v33, 0, 5, vcc
  v_and_b32 v34, 3, v32
  v_lshrrev_b32 v35, 1, v34
  v_add_u32 v34, v34, v35
  v_cmp_gt_u32 vcc, 8, v32
  s_nop 1
  v_cndmask_b32 v34, 2, v34, vcc
  v_add_u32 v33, v33, v34
  v_lshrrev_b32 v34, 2, v32
  v_and_b32 v35, 1, v32
  v_cndmask_b32 v34, v35, v34, vcc
  v_mul_u32_u24 v34, 80, v34
  v_add_u32 v33, v33, v34
  v_lshlrev_b32 v33, 4, v33
  v_mul_u32_u24 v34, 3840, v30
  v_add_u32 v39, v33, v34
  v_add_u32 v31, 4, v31
  v_cmp_le_u32 vcc, 20, v31
  v_subrev_u32 v32, 20, v31
  s_nop 0
  v_cndmask_b32 v31, v31, v32, vcc
  v_addc_co_u32 v30, vcc, 3, v30, vcc
  v_cmp_le_u32 vcc, 10, v31
  v_subrev_u32 v32, 10, v31
  s_nop 0
  v_cndmask_b32 v32, v31, v32, vcc
  v_cndmask_b32 v33, 0, 5, vcc
  v_and_b32 v34, 3, v32
  v_lshrrev_b32 v35, 1, v34
  v_add_u32 v34, v34, v35
  v_cmp_gt_u32 vcc, 8, v32
  s_nop 1
  v_cndmask_b32 v34, 2, v34, vcc
  v_add_u32 v33, v33, v34
  v_lshrrev_b32 v34, 2, v32
  v_and_b32 v35, 1, v32
  v_cndmask_b32 v34, v35, v34, vcc
  v_mul_u32_u24 v34, 80, v34
  v_add_u32 v33, v33, v34
  v_lshlrev_b32 v33, 4, v33
  v_mul_u32_u24 v34, 3840, v30
  v_add_u32 v40, v33, v34
  s_mul_i32 s24, s36, 160
  s_add_u32 s24, s24, 1280
  s_mul_i32 s48, s7, 61440
  s_add_u32 s24, s24, s48
  s_mul_i32 s43, s39, 245760
  s_add_u32 s43, s43, s24
  s_lshl_b32 s44, s39, 7
  s_add_u32 s44, s44, s25
  s_mul_i32 s12, s7, 4096
  s_add_u32 s12, s12, s40
  s_mul_i32 s13, s7, 5120
  s_add_u32 s13, s13, s40
  s_add_u32 m0, s13, 0
  s_nop 0
  buffer_load_dwordx4 v36, s[60:63], s43 offen lds
  s_add_u32 m0, s13, 1024
  s_nop 0
  buffer_load_dwordx4 v37, s[60:63], s43 offen lds
  s_add_u32 m0, s13, 2048
  s_nop 0
  buffer_load_dwordx4 v38, s[60:63], s43 offen lds
  s_add_u32 m0, s13, 3072
  s_nop 0
  buffer_load_dwordx4 v39, s[60:63], s43 offen lds
  s_add_u32 m0, s13, 4096
  s_nop 0
  buffer_load_dwordx4 v40, s[60:63], s43 offen lds
  s_add_u32 s39, s39, 1
  s_cmp_eq_u32 s39, 10
  s_cselect_b32 s39, 0, s39
  s_add_u32 s40, s40, 36864
  s_cmp_eq_u32 s40, 147456
  s_cselect_b32 s40, 0, s40
  s_mov_b32 s68, s8
  s_mov_b32 s69, s9
  s_mov_b32 s70, 25600
  s_mov_b32 s71, 0x20000
  s_mul_i32 s48, s36, 3200
  s_lshl_b32 s49, s7, 10
  s_add_u32 s48, s48, s49
  v_lshlrev_b32 v48, 4, v1
  s_add_u32 m0, s49, 151552
  s_nop 0
  buffer_load_dwordx4 v48, s[68:71], s48 offen lds
L_nophi_78:
  s_cmp_lg_u32 s7, 3
  s_cbranch_scc1 L_nozero_79
  v_mov_b32 v44, 0
  v_mov_b32 v45, 0
  v_mov_b32 v46, 0
  v_mov_b32 v47, 0
  v_lshlrev_b32 v48, 4, v1
  v_add_u32 v48, 155648, v48
  ds_write_b128 v48, v[44:47]
  v_mov_b32 v48, 163136
  ds_write_b32 v48, v44
  s_waitcnt lgkmcnt(0)
L_nozero_79:
  s_mul_i32 s43, s39, 245760
  s_add_u32 s43, s43, s24
  s_lshl_b32 s44, s39, 7
  s_add_u32 s44, s44, s25
  s_mul_i32 s12, s7, 4096
  s_add_u32 s12, s12, s40
  s_mul_i32 s13, s7, 5120
  s_add_u32 s13, s13, s40
  s_add_u32 m0, s12, 20480
  s_nop 0
  buffer_load_dwordx4 v28, s[56:59], s44 offen lds
  s_add_u32 m0, s13, 0
  s_nop 0
  buffer_load_dwordx4 v36, s[60:63], s43 offen lds
  s_add_u32 m0, s13, 1024
  s_nop 0
  buffer_load_dwordx4 v37, s[60:63], s43 offen lds
  s_add_u32 s48, s44, 10240
  s_add_u32 m0, s12, 21504
  s_nop 0
  buffer_load_dwordx4 v29, s[56:59], s48 offen lds
  s_add_u32 m0, s13, 2048
  s_nop 0
  buffer_load_dwordx4 v38, s[60:63], s43 offen lds
  s_add_u32 s48, s44, 20480
  s_add_u32 m0, s12, 22528
  s_nop 0
  buffer_load_dwordx4 v28, s[56:59], s48 offen lds
  s_add_u32 m0, s13, 3072
  s_nop 0
  buffer_load_dwordx4 v39, s[60:63], s43 offen lds
  s_add_u32 s48, s44, 30720
  s_add_u32 m0, s12, 23552
  s_nop 0
  buffer_load_dwordx4 v29, s[56:59], s48 offen lds
  s_add_u32 m0, s13, 4096
  s_nop 0
  buffer_load_dwordx4 v40, s[60:63], s43 offen lds
  s_add_u32 s39, s39, 1
  s_cmp_eq_u32 s39, 10
  s_cselect_b32 s39, 0, s39
  s_add_u32 s40, s40, 36864
  s_cmp_eq_u32 s40, 147456
  s_cselect_b32 s40, 0, s40
  s_waitcnt lgkmcnt(0)
  s_mul_i32 s29, s30, 0x9E3779B1
  s_add_u32 s29, s29, 0x7F4A7C15
  v_mov_b32 v30, 0
  s_mov_b32 s38, 0
  s_waitcnt lgkmcnt(0)
L_lloop_KV:
  s_cmp_eq_u32 s38, 9
  s_cbranch_scc1 L_hw2_80
  s_waitcnt vmcnt(9)
  s_branch L_hgo_81
L_hw2_80:
  s_waitcnt vmcnt(10)
L_hgo_81:
  s_barrier
  s_cmp_lg_u32 s38, 8
  s_cbranch_scc1 L_side_82
  v_min_u32 v30, 19, v1
  v_lshlrev_b32 v30, 4, v30
  s_mul_i32 s48, s7, 320
  v_add_u32 v30, s48, v30
  s_mul_i32 s48, s36, 12800
  s_add_u32 s48, s48, 6029312
  buffer_load_dwordx4 v[44:47], v30, s[64:67], s48 offen sc1
  s_add_u32 s48, s48, 1280
  buffer_load_dwordx4 v[48:51], v30, s[64:67], s48 offen sc1
  s_add_u32 s48, s48, 1280
  buffer_load_dwordx4 v[52:55], v30, s[64:67], s48 offen sc1
  s_add_u32 s48, s48, 1280
  buffer_load_dwordx4 v[56:59], v30, s[64:67], s48 offen sc1
  s_add_u32 s48, s48, 1280
  buffer_load_dwordx4 v[60:63], v30, s[64:67], s48 offen sc1
  s_add_u32 s48, s48, 1280
  buffer_load_dwordx4 v[64:67], v30, s[64:67], s48 offen sc1
  s_add_u32 s48, s48, 1280
  buffer_load_dwordx4 v[68:71], v30, s[64:67], s48 offen sc1
  s_add_u32 s48, s48, 1280
  buffer_load_dwordx4 v[72:75], v30, s[64:67], s48 offen sc1
  s_add_u32 s48, s48, 1280
  buffer_load_dwordx4 v[76:79], v30, s[64:67], s48 offen sc1
  s_add_u32 s48, s48, 1280
  buffer_load_dwordx4 v[80:83], v30, s[64:67], s48 offen sc1
L_side_82:
  s_cmp_gt_u32 s38, 7
  s_cbranch_scc1 L_lnodma_83
  s_mul_i32 s43, s39, 245760
  s_add_u32 s43, s43, s24
  s_lshl_b32 s44, s39, 7
  s_add_u32 s44, s44, s25
  s_mul_i32 s12, s7, 4096
  s_add_u32 s12, s12, s40
  s_mul_i32 s13, s7, 5120
  s_add_u32 s13, s13, s40
  s_add_u32 m0, s12, 20480
  s_nop 0
  buffer_load_dwordx4 v28, s[56:59], s44 offen lds
  s_add_u32 m0, s13, 0
  s_nop 0
  buffer_load_dwordx4 v36, s[60:63], s43 offen lds
  s_add_u32 m0, s13, 1024
  s_nop 0
  buffer_load_dwordx4 v37, s[60:63], s43 offen lds
  s_add_u32 s48, s44, 10240
  s_add_u32 m0, s12, 21504
  s_nop 0
  buffer_load_dwordx4 v29, s[56:59], s48 offen lds
  s_add_u32 m0, s13, 2048
  s_nop 0
  buffer_load_dwordx4 v38, s[60:63], s43 offen lds
  s_add_u32 s48, s44, 20480
  s_add_u32 m0, s12, 22528
  s_nop 0
  buffer_load_dwordx4 v28, s[56:59], s48 offen lds
  s_add_u32 m0, s13, 3072
  s_nop 0
  buffer_load_dwordx4 v39, s[60:63], s43 offen lds
  s_add_u32 s48, s44, 30720
  s_add_u32 m0, s12, 23552
  s_nop 0
  buffer_load_dwordx4 v29, s[56:59], s48 offen lds
  s_add_u32 m0, s13, 4096
  s_nop 0
  buffer_load_dwordx4 v40, s[60:63], s43 offen lds
  s_add_u32 s39, s39, 1
  s_cmp_eq_u32 s39, 10
  s_cselect_b32 s39, 0, s39
  s_add_u32 s40, s40, 36864
  s_cmp_eq_u32 s40, 147456
  s_cselect_b32 s40, 0, s40
L_lnodma_83:
  s_cmp_lg_u32 s38, 0
  s_cbranch_scc1 L_side_84
  s_cmp_lg_u32 s7, 2
  s_cbranch_scc1 L_side_84
  v_and_b32 v25, 7, v1
  v_lshlrev_b32 v25, 2, v25
  v_add_u32 v25, 156672, v25
  ds_read_b32 v26, v25
  s_waitcnt lgkmcnt(0)
  s_nop 1
  v_max_u32_dpp v26, v26, v26 row_shr:1 row_mask:0xf bank_mask:0xf bound_ctrl:0
  s_nop 1
  v_max_u32_dpp v26, v26, v26 row_shr:2 row_mask:0xf bank_mask:0xf bound_ctrl:0
  s_nop 1
  v_max_u32_dpp v26, v26, v26 row_shr:4 row_mask:0xf bank_mask:0xf bound_ctrl:0
  s_nop 1
  v_readlane_b32 s48, v26, 7
  s_lshl_b32 s49, s2, 3
  s_add_u32 s49, s49, 36864
  v_mov_b32 v26, s48
  v_mov_b32 v27, s29
  v_mov_b32 v25, 0
  s_mov_b64 exec, 1
  buffer_store_dwordx2 v[26:27], v25, s[64:67], s49 offen sc1
  s_mov_b64 exec, -1
L_side_84:
  s_cmp_lg_u32 s38, 4
  s_cbranch_scc1 L_side_85
  s_cmp_lg_u32 s7, 1
  s_cbranch_scc1 L_side_85
  s_cmp_ge_u32 s37, 10
  s_cbranch_scc1 L_nocspub_86
  v_lshlrev_b32 v30, 2, v1
  v_add_u32 v30, 156800, v30
  ds_read_b32 v44, v30 offset:0
  ds_read_b32 v45, v30 offset:640
  ds_read_b32 v46, v30 offset:1280
  ds_read_b32 v47, v30 offset:1920
  ds_read_b32 v52, v30 offset:256
  ds_read_b32 v53, v30 offset:896
  ds_read_b32 v54, v30 offset:1536
  ds_read_b32 v55, v30 offset:2176
  ds_read_b32 v60, v30 offset:512
  ds_read_b32 v61, v30 offset:1152
  ds_read_b32 v62, v30 offset:1792
  ds_read_b32 v63, v30 offset:2432
  v_lshrrev_b32 v31, 5, v1
  v_add_u32 v31, s45, v31
  v_subrev_u32 v32, 10, v31
  v_cmp_le_u32 vcc, 10, v31
  s_nop 1
  v_cndmask_b32 v31, v31, v32, vcc
  v_mul_u32_u24 v31, 1280, v31
  v_lshlrev_b32 v30, 3, v1
  v_add_u32 v31, v31, v30
  s_add_u32 s49, s45, 2
  s_cmp_ge_u32 s49, 10
  s_cselect_b32 s50, 10, 0
  s_sub_u32 s49, s49, s50
  s_mul_i32 s49, s49, 1280
  s_mul_i32 s48, s36, 12800
  s_add_u32 s48, s48, 6029312
  s_add_u32 s49, s49, s48
  s_waitcnt lgkmcnt(0)
  v_add_f32 v44, v44, v45
  v_add_f32 v46, v46, v47
  v_add_f32 v44, v44, v46
  v_mov_b32 v45, s29
  v_add_f32 v52, v52, v53
  v_add_f32 v54, v54, v55
  v_add_f32 v52, v52, v54
  v_mov_b32 v53, s29
  v_add_f32 v60, v60, v61
  v_add_f32 v62, v62, v63
  v_add_f32 v60, v60, v62
  v_mov_b32 v61, s29
  buffer_store_dwordx2 v[44:45], v31, s[64:67], s48 offen sc1
  buffer_store_dwordx2 v[52:53], v31, s[64:67], s48 offen offset:512 sc1
  s_mov_b32 exec_hi, 0
  buffer_store_dwordx2 v[60:61], v30, s[64:67], s49 offen offset:1024 sc1
  s_mov_b64 exec, -1
L_nocspub_86:
L_side_85:
  s_cmp_lg_u32 s38, 9
  s_cbranch_scc1 L_side_87
  s_mov_b32 s51, 0
  s_waitcnt vmcnt(0)
L_csg_again_88:
  s_mov_b64 s[52:53], 0
  v_cmp_ne_u32 vcc, s29, v45
  s_nop 0
  s_or_b64 s[52:53], s[52:53], vcc
  v_cmp_ne_u32 vcc, s29, v47
  s_nop 0
  s_or_b64 s[52:53], s[52:53], vcc
  v_cmp_ne_u32 vcc, s29, v49
  s_nop 0
  s_or_b64 s[52:53], s[52:53], vcc
  v_cmp_ne_u32 vcc, s29, v51
  s_nop 0
  s_or_b64 s[52:53], s[52:53], vcc
  v_cmp_ne_u32 vcc, s29, v53
  s_nop 0
  s_or_b64 s[52:53], s[52:53], vcc
  v_cmp_ne_u32 vcc, s29, v55
  s_nop 0
  s_or_b64 s[52:53], s[52:53], vcc
  v_cmp_ne_u32 vcc, s29, v57
  s_nop 0
  s_or_b64 s[52:53], s[52:53], vcc
  v_cmp_ne_u32 vcc, s29, v59
  s_nop 0
  s_or_b64 s[52:53], s[52:53], vcc
  v_cmp_ne_u32 vcc, s29, v61
  s_nop 0
  s_or_b64 s[52:53], s[52:53], vcc
  v_cmp_ne_u32 vcc, s29, v63
  s_nop 0
  s_or_b64 s[52:53], s[52:53], vcc
  v_cmp_ne_u32 vcc, s29, v65
  s_nop 0
  s_or_b64 s[52:53], s[52:53], vcc
  v_cmp_ne_u32 vcc, s29, v67
  s_nop 0
  s_or_b64 s[52:53], s[52:53], vcc
  v_cmp_ne_u32 vcc, s29, v69
  s_nop 0
  s_or_b64 s[52:53], s[52:53], vcc
  v_cmp_ne_u32 vcc, s29, v71
  s_nop 0
  s_or_b64 s[52:53], s[52:53], vcc
  v_cmp_ne_u32 vcc, s29, v73
  s_nop 0
  s_or_b64 s[52:53], s[52:53], vcc
  v_cmp_ne_u32 vcc, s29, v75
  s_nop 0
  s_or_b64 s[52:53], s[52:53], vcc
  v_cmp_ne_u32 vcc, s29, v77
  s_nop 0
  s_or_b64 s[52:53], s[52:53], vcc
  v_cmp_ne_u32 vcc, s29, v79
  s_nop 0
  s_or_b64 s[52:53], s[52:53], vcc
  v_cmp_ne_u32 vcc, s29, v81
  s_nop 0
  s_or_b64 s[52:53], s[52:53], vcc
  v_cmp_ne_u32 vcc, s29, v83
  s_nop 0
  s_or_b64 s[52:53], s[52:53], vcc
  s_cmp_eq_u64 s[52:53], 0
  s_cbranch_scc1 L_csg_ok_89
  s_add_u32 s51, s51, 1
  s_cmp_gt_u32 s51, 40000
  s_cbranch_scc1 L_csg_ok_89
  v_min_u32 v30, 19, v1
  v_lshlrev_b32 v30, 4, v30
  s_mul_i32 s48, s7, 320
  v_add_u32 v30, s48, v30
  s_mul_i32 s48, s36, 12800
  s_add_u32 s48, s48, 6029312
  buffer_load_dwordx4 v[44:47], v30, s[64:67], s48 offen sc1
  s_add_u32 s48, s48, 1280
  buffer_load_dwordx4 v[48:51], v30, s[64:67], s48 offen sc1
  s_add_u32 s48, s48, 1280
  buffer_load_dwordx4 v[52:55], v30, s[64:67], s48 offen sc1
  s_add_u32 s48, s48, 1280
  buffer_load_dwordx4 v[56:59], v30, s[64:67], s48 offen sc1
  s_add_u32 s48, s48, 1280
  buffer_load_dwordx4 v[60:63], v30, s[64:67], s48 offen sc1
  s_add_u32 s48, s48, 1280
  buffer_load_dwordx4 v[64:67], v30, s[64:67], s48 offen sc1
  s_add_u32 s48, s48, 1280
  buffer_load_dwordx4 v[68:71], v30, s[64:67], s48 offen sc1
  s_add_u32 s48, s48, 1280
  buffer_load_dwordx4 v[72:75], v30, s[64:67], s48 offen sc1
  s_add_u32 s48, s48, 1280
  buffer_load_dwordx4 v[76:79], v30, s[64:67], s48 offen sc1
  s_add_u32 s48, s48, 1280
  buffer_load_dwordx4 v[80:83], v30, s[64:67], s48 offen sc1
  s_waitcnt vmcnt(0)
  s_branch L_csg_again_88
L_csg_ok_89:
  v_add_f32 v44, v44, v48
  v_add_f32 v46, v46, v50
  v_add_f32 v44, v44, v52
  v_add_f32 v46, v46, v54
  v_add_f32 v44, v44, v56
  v_add_f32 v46, v46, v58
  v_add_f32 v44, v44, v60
  v_add_f32 v46, v46, v62
  v_add_f32 v44, v44, v64
  v_add_f32 v46, v46, v66
  v_add_f32 v44, v44, v68
  v_add_f32 v46, v46, v70
  v_add_f32 v44, v44, v72
  v_add_f32 v46, v46, v74
  v_add_f32 v44, v44, v76
  v_add_f32 v46, v46, v78
  v_add_f32 v44, v44, v80
  v_add_f32 v46, v46, v82
  v_min_u32 v30, 19, v1
  v_lshlrev_b32 v30, 5, v30
  s_mul_i32 s48, s7, 640
  s_add_u32 s48, s48, 159296
  v_add_u32 v30, s48, v30
  v_cvt_pk_bf16_f32 v52, v44, 0
  v_lshlrev_b32 v32, 16, v52
  v_sub_f32 v32, v44, v32
  v_cvt_pk_bf16_f32 v54, v32, 0
  v_mov_b32 v53, 0
  v_mov_b32 v55, 0
  v_cvt_pk_bf16_f32 v56, v46, 0
  v_lshlrev_b32 v32, 16, v56
  v_sub_f32 v32, v46, v32
  v_cvt_pk_bf16_f32 v58, v32, 0
  v_mov_b32 v57, 0
  v_mov_b32 v59, 0
  s_mov_b64 exec, 0xfffff
  ds_write_b128 v30, v[52:55]
  ds_write_b128 v30, v[56:59] offset:16
  s_mov_b64 exec, -1
  s_waitcnt lgkmcnt(0)
L_side_87:
  s_cmp_lg_u32 s38, 9
  s_cbranch_scc1 L_side_90
  s_cmp_lg_u32 s7, 3
  s_cbranch_scc1 L_side_90
  v_lshlrev_b32 v12, 3, v1
  v_add_u32 v12, 36864, v12
  buffer_load_dwordx2 v[4:5], v12, s[64:67], 0 offen offset:0 sc1
  buffer_load_dwordx2 v[6:7], v12, s[64:67], 0 offen offset:512 sc1
  buffer_load_dwordx2 v[8:9], v12, s[64:67], 0 offen offset:1024 sc1
  buffer_load_dwordx2 v[10:11], v12, s[64:67], 0 offen offset:1536 sc1
L_side_90:
  s_add_u32 s38, s38, 1
  s_cmp_lt_u32 s38, 10
  s_cbranch_scc1 L_lloop_KV
  s_barrier
  s_cmp_lg_u32 s7, 3
  s_cbranch_scc1 L_only_91
  s_waitcnt vmcnt(0)
  s_mov_b32 s50, 0
L_sel_again_92:
  v_cmp_ne_u32 vcc, s29, v5
  v_cmp_ne_u32 s[48:49], s29, v7
  s_nop 1
  s_or_b64 vcc, vcc, s[48:49]
  v_cmp_ne_u32 s[48:49], s29, v9
  s_nop 1
  s_or_b64 vcc, vcc, s[48:49]
  v_cmp_ne_u32 s[48:49], s29, v11
  s_nop 1
  s_or_b64 vcc, vcc, s[48:49]
  s_cbranch_vccz L_sel_ok_93
  s_add_u32 s50, s50, 1
  s_cmp_gt_u32 s50, 40000
  s_cbranch_scc1 L_sel_ok_93
  v_lshlrev_b32 v12, 3, v1
  v_add_u32 v12, 36864, v12
  buffer_load_dwordx2 v[4:5], v12, s[64:67], 0 offen offset:0 sc1
  buffer_load_dwordx2 v[6:7], v12, s[64:67], 0 offen offset:512 sc1
  buffer_load_dwordx2 v[8:9], v12, s[64:67], 0 offen offset:1024 sc1
  buffer_load_dwordx2 v[10:11], v12, s[64:67], 0 offen offset:1536 sc1
  s_waitcnt vmcnt(0)
  s_branch L_sel_again_92
L_sel_ok_93:
  v_max_u32 v4, v4, v6
  v_max_u32 v8, v8, v10
  v_max_u32 v4, v4, v8
  s_nop 1
  v_max_u32_dpp v4, v4, v4 row_shr:1 row_mask:0xf bank_mask:0xf bound_ctrl:0
  s_nop 1
  v_max_u32_dpp v4, v4, v4 row_shr:2 row_mask:0xf bank_mask:0xf bound_ctrl:0
  s_nop 1
  v_max_u32_dpp v4, v4, v4 row_shr:4 row_mask:0xf bank_mask:0xf bound_ctrl:0
  s_nop 1
  v_max_u32_dpp v4, v4, v4 row_shr:8 row_mask:0xf bank_mask:0xf bound_ctrl:0
  s_nop 1
  v_max_u32_dpp v4, v4, v4 row_bcast:15 row_mask:0xa bank_mask:0xf
  s_nop 1
  v_max_u32_dpp v4, v4, v4 row_bcast:31 row_mask:0xc bank_mask:0xf
  s_nop 0
  v_readlane_b32 s47, v4, 63
  s_nop 0
  s_and_b32 s46, s47, 2047
  s_sub_u32 s46, 2047, s46
  s_cmp_lg_u32 s2, 0
  s_cbranch_scc1 L_noepoch_94
  s_add_u32 s50, s30, 1
  v_mov_b32 v6, s50
  v_mov_b32 v7, 0
  s_mov_b64 exec, 1
  buffer_store_dword v6, v7, s[64:67], 0 offen sc1
  s_mov_b64 exec, -1
L_noepoch_94:
  v_mov_b32 v8, s46
  v_mov_b32 v9, s47
  v_mov_b32 v12, 156736
  s_mov_b64 exec, 1
  ds_write_b64 v12, v[8:9]
  s_mov_b64 exec, -1
  s_waitcnt lgkmcnt(0)
  s_mul_i32 s50, s46, 1280
  v_lshlrev_b32 v12, 2, v1
  buffer_load_dword v14, v12, s[56:59], s50 offen offset:0
  buffer_load_dword v15, v12, s[56:59], s50 offen offset:256
  buffer_load_dword v16, v12, s[56:59], s50 offen offset:512
  buffer_load_dword v17, v12, s[56:59], s50 offen offset:768
  buffer_load_dword v18, v12, s[56:59], s50 offen offset:1024
  s_lshl_b32 s50, s46, 4
  s_add_u32 s50, s50, 4096
  v_mov_b32 v13, 0
  buffer_load_dwordx4 v[20:23], v13, s[64:67], s50 offen sc1
L_only_91:
  s_mov_b32 s48, 429496730
  v_mul_hi_u32 v24, v0, s48
  v_mul_u32_u24 v25, 10, v24
  v_sub_u32 v25, v0, v25
  s_lshl_b32 s48, s4, 6
  v_min_u32 v24, 63, v24
  v_add_u32 v26, s48, v24
  v_mul_u32_u24 v36, 1280, v26
  v_lshl_add_u32 v36, v25, 4, v36
  s_mul_i32 s48, s5, 160
  buffer_load_dwordx4 v[28:31], v36, s[56:59], s48 offen
  v_lshlrev_b32 v37, 4, v26
  v_add_u32 v37, 4096, v37
  buffer_load_dwordx4 v[32:35], v37, s[64:67], 0 offen sc1
  s_mov_b32 s72, s10
  s_mov_b32 s73, s11
  s_mov_b32 s74, 819200
  s_mov_b32 s75, 0x20000
  v_lshrrev_b32 v36, 3, v1
  v_mul_u32_u24 v37, 1280, v36
  v_bfe_u32 v38, v1, 4, 1
  v_and_b32 v39, 7, v1
  s_mul_i32 s76, s5, 160
  s_mul_i32 s49, s7, 204800
  s_add_u32 s76, s76, s49
  v_lshlrev_b32 v40, 1, v38
  v_or_b32 v40, 0, v40
  v_xor_b32 v40, v40, v39
  v_lshl_add_u32 v42, v40, 4, v37
  v_lshlrev_b32 v40, 1, v38
  v_or_b32 v40, 4, v40
  v_xor_b32 v40, v40, v39
  v_lshl_add_u32 v43, v40, 4, v37
  s_mul_i32 s77, s7, 20480
  s_add_u32 s77, s77, 0
  v_lshrrev_b32 v36, 4, v1
  v_bfe_u32 v37, v1, 1, 3
  v_and_b32 v38, 1, v36
  v_lshlrev_b32 v38, 2, v38
  v_xor_b32 v37, v37, v38
  v_and_b32 v38, 1, v1
  v_lshlrev_b32 v38, 4, v38
  v_add_u32 v38, 128, v38
  s_mul_i32 s78, s7, 5120
  s_add_u32 s78, s78, 81920
  v_add_u32 v39, 0, v36
  s_mov_b32 s52, 858993460
  v_mul_hi_u32 v40, v39, s52
  v_mul_u32_u24 v41, 5, v40
  v_sub_u32 v41, v39, v41
  v_lshrrev_b32 v39, 1, v41
  v_add_u32 v39, v41, v39
  v_cmp_gt_u32 vcc, 4, v41
  s_nop 1
  v_cndmask_b32 v39, 2, v39, vcc
  v_mad_u32_u24 v39, v40, 5, v39
  v_lshl_add_u32 v39, v39, 3, v37
  v_mul_u32_u24 v39, 1280, v39
  v_add_u32 v44, v39, v38
  v_add_u32 v39, 4, v36
  s_mov_b32 s52, 858993460
  v_mul_hi_u32 v40, v39, s52
  v_mul_u32_u24 v41, 5, v40
  v_sub_u32 v41, v39, v41
  v_lshrrev_b32 v39, 1, v41
  v_add_u32 v39, v41, v39
  v_cmp_gt_u32 vcc, 4, v41
  s_nop 1
  v_cndmask_b32 v39, 2, v39, vcc
  v_mad_u32_u24 v39, v40, 5, v39
  v_lshl_add_u32 v39, v39, 3, v37
  v_mul_u32_u24 v39, 1280, v39
  v_add_u32 v45, v39, v38
  v_add_u32 v39, 8, v36
  s_mov_b32 s52, 858993460
  v_mul_hi_u32 v40, v39, s52
  v_mul_u32_u24 v41, 5, v40
  v_sub_u32 v41, v39, v41
  v_lshrrev_b32 v39, 1, v41
  v_add_u32 v39, v41, v39
  v_cmp_gt_u32 vcc, 4, v41
  s_nop 1
  v_cndmask_b32 v39, 2, v39, vcc
  v_mad_u32_u24 v39, v40, 5, v39
  v_lshl_add_u32 v39, v39, 3, v37
  v_mul_u32_u24 v39, 1280, v39
  v_add_u32 v46, v39, v38
  v_add_u32 v39, 12, v36
  s_mov_b32 s52, 858993460
  v_mul_hi_u32 v40, v39, s52
  v_mul_u32_u24 v41, 5, v40
  v_sub_u32 v41, v39, v41
  v_lshrrev_b32 v39, 1, v41
  v_add_u32 v39, v41, v39
  v_cmp_gt_u32 vcc, 4, v41
  s_nop 1
  v_cndmask_b32 v39, 2, v39, vcc
  v_mad_u32_u24 v39, v40, 5, v39
  v_lshl_add_u32 v39, v39, 3, v37
  v_mul_u32_u24 v39, 1280, v39
  v_add_u32 v47, v39, v38
  v_add_u32 v39, 16, v36
  s_mov_b32 s52, 858993460
  v_mul_hi_u32 v40, v39, s52
  v_mul_u32_u24 v41, 5, v40
  v_sub_u32 v41, v39, v41
  v_lshrrev_b32 v39, 1, v41
  v_add_u32 v39, v41, v39
  v_cmp_gt_u32 vcc, 4, v41
  s_nop 1
  v_cndmask_b32 v39, 2, v39, vcc
  v_mad_u32_u24 v39, v40, 5, v39
  v_lshl_add_u32 v39, v39, 3, v37
  v_mul_u32_u24 v39, 1280, v39
  v_add_u32 v48, v39, v38
  s_cmp_ge_u32 s6, 108
  s_cbranch_scc1 L_nomoe_h0_95
  v_lshrrev_b32 v36, 3, v1
  v_mul_u32_u24 v36, 3456, v36
  v_bfe_u32 v37, v1, 4, 1
  v_lshlrev_b32 v37, 2, v37
  v_xor_b32 v37, v37, v1
  v_and_b32 v37, 7, v37
  v_lshl_add_u32 v36, v37, 4, v36
  s_lshr_b32 s48, s6, 2
  s_lshl_b32 s48, s48, 7
  s_and_b32 s49, s6, 3
  s_mul_i32 s49, s49, 160
  s_mul_i32 s50, s7, 40
  s_add_u32 s49, s49, s50
  s_mul_i32 s49, s49, 3456
  s_add_u32 s48, s48, s49
  s_mul_i32 s49, s7, 5120
  s_mov_b32 s68, s16
  s_mov_b32 s69, s17
  s_mov_b32 s70, 2211840
  s_mov_b32 s71, 0x20000
  s_add_u32 m0, s49, 102400
  s_add_u32 s50, s48, 0
  buffer_load_dwordx4 v36, s[68:71], s50 offen lds
  s_add_u32 m0, s49, 103424
  s_add_u32 s50, s48, 27648
  buffer_load_dwordx4 v36, s[68:71], s50 offen lds
  s_add_u32 m0, s49, 104448
  s_add_u32 s50, s48, 55296
  buffer_load_dwordx4 v36, s[68:71], s50 offen lds
  s_add_u32 m0, s49, 105472
  s_add_u32 s50, s48, 82944
  buffer_load_dwordx4 v36, s[68:71], s50 offen lds
  s_add_u32 m0, s49, 106496
  s_add_u32 s50, s48, 110592
  buffer_load_dwordx4 v36, s[68:71], s50 offen lds
  s_mov_b32 s68, s18
  s_mov_b32 s69, s19
  s_mov_b32 s70, 2211840
  s_mov_b32 s71, 0x20000
  s_add_u32 m0, s49, 123008
  s_add_u32 s50, s48, 0
  buffer_load_dwordx4 v36, s[68:71], s50 offen lds
  s_add_u32 m0, s49, 124032
  s_add_u32 s50, s48, 27648
  buffer_load_dwordx4 v36, s[68:71], s50 offen lds
  s_add_u32 m0, s49, 125056
  s_add_u32 s50, s48, 55296
  buffer_load_dwordx4 v36, s[68:71], s50 offen lds
  s_add_u32 m0, s49, 126080
  s_add_u32 s50, s48, 82944
  buffer_load_dwordx4 v36, s[68:71], s50 offen lds
  s_add_u32 m0, s49, 127104
  s_add_u32 s50, s48, 110592
  buffer_load_dwordx4 v36, s[68:71], s50 offen lds
L_nomoe_h0_95:
  s_barrier
  s_setprio 0
  s_cmp_lg_u32 s7, 0
  s_cbranch_scc1 L_only_96
  s_setprio 3
L_only_96:
  s_waitcnt vmcnt(0) lgkmcnt(0)
  s_cmp_lg_u32 s7, 3
  s_cbranch_scc1 L_only_97
  s_mov_b32 s51, 0
L_sst_again_98:
  v_cmp_ne_u32 vcc, s29, v21
  v_cmp_ne_u32 s[48:49], s29, v23
  s_nop 1
  s_or_b64 vcc, vcc, s[48:49]
  s_cbranch_vccz L_sst_ok_99
  s_add_u32 s51, s51, 1
  s_cmp_gt_u32 s51, 40000
  s_cbranch_scc1 L_sst_ok_99
  s_lshl_b32 s50, s46, 4
  s_add_u32 s50, s50, 4096
  buffer_load_dwordx4 v[20:23], v13, s[64:67], s50 offen sc1
  s_waitcnt vmcnt(0)
  s_branch L_sst_again_98
L_sst_ok_99:
  v_mul_f32 v4, v20, v22
  v_lshlrev_b32 v6, 16, v14
  v_and_b32 v7, s34, v14
  v_fma_f32 v6, v6, v22, -v4
  v_fma_f32 v7, v7, v22, -v4
  v_cvt_pk_bf16_f32 v8, v6, v7
  v_add_u32 v9, 156800, v12
  ds_write_b32 v9, v8
  v_lshlrev_b32 v6, 16, v15
  v_and_b32 v7, s34, v15
  v_fma_f32 v6, v6, v22, -v4
  v_fma_f32 v7, v7, v22, -v4
  v_cvt_pk_bf16_f32 v8, v6, v7
  v_add_u32 v9, 157056, v12
  ds_write_b32 v9, v8
  v_lshlrev_b32 v6, 16, v16
  v_and_b32 v7, s34, v16
  v_fma_f32 v6, v6, v22, -v4
  v_fma_f32 v7, v7, v22, -v4
  v_cvt_pk_bf16_f32 v8, v6, v7
  v_add_u32 v9, 157312, v12
  ds_write_b32 v9, v8
  v_lshlrev_b32 v6, 16, v17
  v_and_b32 v7, s34, v17
  v_fma_f32 v6, v6, v22, -v4
  v_fma_f32 v7, v7, v22, -v4
  v_cvt_pk_bf16_f32 v8, v6, v7
  v_add_u32 v9, 157568, v12
  ds_write_b32 v9, v8
  v_lshlrev_b32 v6, 16, v18
  v_and_b32 v7, s34, v18
  v_fma_f32 v6, v6, v22, -v4
  v_fma_f32 v7, v7, v22, -v4
  v_cvt_pk_bf16_f32 v8, v6, v7
  v_add_u32 v9, 157824, v12
  ds_write_b32 v9, v8
  s_waitcnt lgkmcnt(0)
L_only_97:
  s_barrier
  s_cmp_lg_u32 s7, 0
  s_cbranch_scc1 L_only_100
  s_lshl_b32 s48, s36, 10
  s_lshl_b32 s49, s37, 2
  s_add_u32 s48, s48, s49
  s_add_u32 s48, s48, 65536
  v_mov_b32 v3, s29
  v_lshlrev_b32 v4, 7, v1
  s_mov_b64 s[54:55], exec
  s_mov_b64 exec, 0xff
  buffer_store_dword v3, v4, s[64:67], s48 offen sc1
  s_mov_b64 exec, s[54:55]
L_only_100:
  s_add_u32 m0, s77, 0
  s_add_u32 s79, s76, 0
  buffer_load_dwordx4 v42, s[72:75], s79 offen lds
  s_waitcnt vmcnt(2)
  s_add_u32 m0, s77, 1024
  s_add_u32 s79, s76, 10240
  buffer_load_dwordx4 v43, s[72:75], s79 offen lds
  s_waitcnt vmcnt(2)
  s_add_u32 m0, s77, 2048
  s_add_u32 s79, s76, 30720
  buffer_load_dwordx4 v42, s[72:75], s79 offen lds
  s_waitcnt vmcnt(2)
  s_add_u32 m0, s77, 3072
  s_add_u32 s79, s76, 40960
  buffer_load_dwordx4 v43, s[72:75], s79 offen lds
  s_waitcnt vmcnt(2)
  s_add_u32 m0, s77, 4096
  s_add_u32 s79, s76, 20480
  buffer_load_dwordx4 v42, s[72:75], s79 offen lds
  s_waitcnt vmcnt(2)
  s_add_u32 m0, s77, 5120
  s_add_u32 s79, s76, 51200
  buffer_load_dwordx4 v43, s[72:75], s79 offen lds
  s_waitcnt vmcnt(2)
  s_add_u32 m0, s77, 6144
  s_add_u32 s79, s76, 61440
  buffer_load_dwordx4 v42, s[72:75], s79 offen lds
  s_waitcnt vmcnt(2)
  s_add_u32 m0, s77, 7168
  s_add_u32 s79, s76, 81920
  buffer_load_dwordx4 v43, s[72:75], s79 offen lds
  s_waitcnt vmcnt(2)
  s_add_u32 m0, s77, 8192
  s_add_u32 s79, s76, 92160
  buffer_load_dwordx4 v42, s[72:75], s79 offen lds
  s_waitcnt vmcnt(2)
  s_add_u32 m0, s77, 9216
  s_add_u32 s79, s76, 71680
  buffer_load_dwordx4 v43, s[72:75], s79 offen lds
  s_waitcnt vmcnt(2)
  s_add_u32 m0, s77, 10240
  s_add_u32 s79, s76, 102400
  buffer_load_dwordx4 v42, s[72:75], s79 offen lds
  s_waitcnt vmcnt(2)
  s_add_u32 m0, s77, 11264
  s_add_u32 s79, s76, 112640
  buffer_load_dwordx4 v43, s[72:75], s79 offen lds
  s_waitcnt vmcnt(2)
  s_add_u32 m0, s77, 12288
  s_add_u32 s79, s76, 133120
  buffer_load_dwordx4 v42, s[72:75], s79 offen lds
  s_waitcnt vmcnt(2)
  s_add_u32 m0, s77, 13312
  s_add_u32 s79, s76, 143360
  buffer_load_dwordx4 v43, s[72:75], s79 offen lds
  s_waitcnt vmcnt(2)
  s_add_u32 m0, s77, 14336
  s_add_u32 s79, s76, 122880
  buffer_load_dwordx4 v42, s[72:75], s79 offen lds
  s_waitcnt vmcnt(2)
  s_add_u32 m0, s77, 15360
  s_add_u32 s79, s76, 153600
  buffer_load_dwordx4 v43, s[72:75], s79 offen lds
  s_waitcnt vmcnt(2)
  s_add_u32 m0, s77, 16384
  s_add_u32 s79, s76, 163840
  buffer_load_dwordx4 v42, s[72:75], s79 offen lds
  s_waitcnt vmcnt(2)
  s_add_u32 m0, s77, 17408
  s_add_u32 s79, s76, 184320
  buffer_load_dwordx4 v43, s[72:75], s79 offen lds
  s_waitcnt vmcnt(2)
  s_add_u32 m0, s77, 18432
  s_add_u32 s79, s76, 194560
  buffer_load_dwordx4 v42, s[72:75], s79 offen lds
  s_waitcnt vmcnt(2)
  s_add_u32 m0, s77, 19456
  s_add_u32 s79, s76, 174080
  buffer_load_dwordx4 v43, s[72:75], s79 offen lds
  s_waitcnt vmcnt(2)
  s_add_u32 m0, s78, 0
  s_nop 0
  buffer_load_dwordx4 v44, s[72:75], s76 offen lds
  s_waitcnt vmcnt(2)
  s_add_u32 m0, s78, 1024
  s_nop 0
  buffer_load_dwordx4 v45, s[72:75], s76 offen lds
  s_waitcnt vmcnt(2)
  s_add_u32 m0, s78, 2048
  s_nop 0
  buffer_load_dwordx4 v46, s[72:75], s76 offen lds
  s_waitcnt vmcnt(2)
  s_add_u32 m0, s78, 3072
  s_nop 0
  buffer_load_dwordx4 v47, s[72:75], s76 offen lds
  s_waitcnt vmcnt(2)
  s_add_u32 m0, s78, 4096
  s_nop 0
  buffer_load_dwordx4 v48, s[72:75], s76 offen lds
  s_waitcnt vmcnt(0) lgkmcnt(0)
  s_barrier
  s_lshr_b32 s72, s4, 2
  s_cmp_lg_u32 s7, 0
  s_cbranch_scc1 L_only_101
  s_lshl_b32 s48, s72, 3
  s_add_u32 s48, s48, s5
  s_lshl_b32 s48, s48, 7
  s_add_u32 s48, s48, 73728
  v_min_u32 v3, 15, v1
  v_lshlrev_b32 v3, 2, v3
  v_add_u32 v3, s48, v3
  s_waitcnt vmcnt(0) lgkmcnt(0)
  s_mov_b32 s50, 0
L_f2_102:
  buffer_load_dword v4, v3, s[64:67], 0 offen sc1
  s_waitcnt vmcnt(0)
  v_cmp_ne_u32 vcc, s29, v4
  s_nop 0
  s_cbranch_vccz L_f2_ok_103
  s_sleep 1
  s_add_u32 s50, s50, 1
  s_cmp_gt_u32 s50, 40000
  s_cbranch_scc0 L_f2_102
L_f2_ok_103:
  s_waitcnt vmcnt(0)
L_only_101:
  s_barrier
  v_mov_b32 v3, 156736
  ds_read_b32 v3, v3
  s_waitcnt lgkmcnt(0)
  v_readfirstlane_b32 s73, v3
  s_nop 0
  s_lshr_b32 s48, s73, 6
  s_cmp_lg_u32 s48, s4
  s_cbranch_scc1 L_noowner_104
  v_min_u32 v3, 53, v1
  v_lshlrev_b32 v3, 2, v3
  v_add_u32 v3, 81920, v3
  s_waitcnt vmcnt(0) lgkmcnt(0)
  s_mov_b32 s50, 0
L_f3a_105:
  buffer_load_dword v6, v3, s[64:67], 0 offen sc1
  s_waitcnt vmcnt(0)
  v_cmp_ne_u32 vcc, s29, v6
  s_nop 0
  s_cbranch_vccz L_f3a_ok_106
  s_sleep 1
  s_add_u32 s50, s50, 1
  s_cmp_gt_u32 s50, 40000
  s_cbranch_scc0 L_f3a_105
L_f3a_ok_106:
  s_waitcnt vmcnt(0)
  v_add_u32 v3, 216, v3
  s_waitcnt vmcnt(0) lgkmcnt(0)
  s_mov_b32 s50, 0
L_f3b_107:
  buffer_load_dword v6, v3, s[64:67], 0 offen sc1
  s_waitcnt vmcnt(0)
  v_cmp_ne_u32 vcc, s29, v6
  s_nop 0
  s_cbranch_vccz L_f3b_ok_108
  s_sleep 1
  s_add_u32 s50, s50, 1
  s_cmp_gt_u32 s50, 40000
  s_cbranch_scc0 L_f3b_107
L_f3b_ok_108:
  s_waitcnt vmcnt(0)
  s_lshl_b32 s48, s7, 6
  v_add_u32 v3, s48, v1
  s_mov_b32 s49, 214748365
  v_mul_hi_u32 v4, v3, s49
  v_mul_u32_u24 v5, 20, v4
  v_sub_u32 v5, v3, v5
  v_cmp_gt_u32 vcc, 240, v3
  s_nop 0
  s_and_saveexec_b64 s[52:53], vcc
  s_cbranch_execz L_noys_109
  v_mul_u32_u24 v3, 23040, v4
  v_lshl_add_u32 v3, v5, 4, v3
  s_mul_i32 s48, s5, 320
  s_add_u32 s48, s48, 5242880
  buffer_load_dwordx4 v[36:39], v3, s[64:67], s48 offen sc1
  s_add_u32 s48, s48, 2560
  buffer_load_dwordx4 v[40:43], v3, s[64:67], s48 offen sc1
  s_add_u32 s48, s48, 2560
  buffer_load_dwordx4 v[44:47], v3, s[64:67], s48 offen sc1
  s_add_u32 s48, s48, 2560
  buffer_load_dwordx4 v[48:51], v3, s[64:67], s48 offen sc1
  s_add_u32 s48, s48, 2560
  buffer_load_dwordx4 v[52:55], v3, s[64:67], s48 offen sc1
  s_add_u32 s48, s48, 2560
  buffer_load_dwordx4 v[56:59], v3, s[64:67], s48 offen sc1
  s_add_u32 s48, s48, 2560
  buffer_load_dwordx4 v[60:63], v3, s[64:67], s48 offen sc1
  s_add_u32 s48, s48, 2560
  buffer_load_dwordx4 v[64:67], v3, s[64:67], s48 offen sc1
  s_add_u32 s48, s48, 2560
  buffer_load_dwordx4 v[68:71], v3, s[64:67], s48 offen sc1
  s_waitcnt vmcnt(7)
  v_add_f32 v8, v36, v40
  v_add_f32 v9, v37, v41
  v_add_f32 v10, v38, v42
  v_add_f32 v11, v39, v43
  s_waitcnt vmcnt(6)
  v_add_f32 v8, v8, v44
  v_add_f32 v9, v9, v45
  v_add_f32 v10, v10, v46
  v_add_f32 v11, v11, v47
  s_waitcnt vmcnt(5)
  v_add_f32 v8, v8, v48
  v_add_f32 v9, v9, v49
  v_add_f32 v10, v10, v50
  v_add_f32 v11, v11, v51
  s_waitcnt vmcnt(4)
  v_add_f32 v8, v8, v52
  v_add_f32 v9, v9, v53
  v_add_f32 v10, v10, v54
  v_add_f32 v11, v11, v55
  s_waitcnt vmcnt(3)
  v_add_f32 v8, v8, v56
  v_add_f32 v9, v9, v57
  v_add_f32 v10, v10, v58
  v_add_f32 v11, v11, v59
  s_waitcnt vmcnt(2)
  v_add_f32 v8, v8, v60
  v_add_f32 v9, v9, v61
  v_add_f32 v10, v10, v62
  v_add_f32 v11, v11, v63
  s_waitcnt vmcnt(1)
  v_add_f32 v8, v8, v64
  v_add_f32 v9, v9, v65
  v_add_f32 v10, v10, v66
  v_add_f32 v11, v11, v67
  s_waitcnt vmcnt(0)
  v_add_f32 v8, v8, v68
  v_add_f32 v9, v9, v69
  v_add_f32 v10, v10, v70
  v_add_f32 v11, v11, v71
  v_mul_u32_u24 v3, 320, v4
  v_lshl_add_u32 v3, v5, 4, v3
  v_add_u32 v3, 159296, v3
  ds_write_b128 v3, v[8:11]
  s_waitcnt lgkmcnt(0)
L_noys_109:
  s_mov_b64 exec, s[52:53]
  s_waitcnt vmcnt(0) lgkmcnt(0)
L_noowner_104:
  s_waitcnt vmcnt(0) lgkmcnt(0)
  s_barrier
  v_cmp_gt_u32 vcc, 640, v0
  s_nop 0
  s_and_saveexec_b64 s[52:53], vcc
  s_cbranch_execz L_noitem_110
  v_mul_u32_u24 v4, 336, v24
  v_lshl_add_u32 v4, v25, 5, v4
  v_add_u32 v4, 102400, v4
  ds_read_b128 v[8:11], v4
  ds_read_b128 v[12:15], v4 offset:16
  ds_read_b128 v[16:19], v4 offset:21504
  ds_read_b128 v[20:23], v4 offset:21520
  s_waitcnt vmcnt(0) lgkmcnt(0)
  s_mov_b32 s50, 0
L_ist_again_111:
  v_cmp_ne_u32 vcc, s29, v33
  v_cmp_ne_u32 s[48:49], s29, v35
  s_nop 1
  s_or_b64 vcc, vcc, s[48:49]
  s_cbranch_vccz L_ist_ok_112
  s_add_u32 s50, s50, 1
  s_cmp_gt_u32 s50, 40000
  s_cbranch_scc1 L_ist_ok_112
  v_lshlrev_b32 v5, 4, v26
  v_add_u32 v5, 4096, v5
  buffer_load_dwordx4 v[32:35], v5, s[64:67], 0 offen sc1
  s_waitcnt vmcnt(0)
  s_branch L_ist_again_111
L_ist_ok_112:
  v_pk_add_f32 v[8:9], v[8:9], v[16:17]
  v_pk_add_f32 v[10:11], v[10:11], v[18:19]
  v_pk_add_f32 v[12:13], v[12:13], v[20:21]
  v_pk_add_f32 v[14:15], v[14:15], v[22:23]
  v_cmp_eq_u32 vcc, s73, v26
  s_nop 0
  s_and_saveexec_b64 s[48:49], vcc
  s_cbranch_execz L_noy_113
  v_lshlrev_b32 v5, 5, v25
  v_add_u32 v5, 159296, v5
  ds_read_b128 v[16:19], v5 offset:0
  ds_read_b128 v[20:23], v5 offset:16
  s_waitcnt lgkmcnt(1)
  v_add_f32 v8, v8, v16
  v_add_f32 v9, v9, v17
  v_add_f32 v10, v10, v18
  v_add_f32 v11, v11, v19
  s_waitcnt lgkmcnt(0)
  v_add_f32 v12, v12, v20
  v_add_f32 v13, v13, v21
  v_add_f32 v14, v14, v22
  v_add_f32 v15, v15, v23
  ds_read_b128 v[16:19], v5 offset:320
  ds_read_b128 v[20:23], v5 offset:336
  s_waitcnt lgkmcnt(1)
  v_add_f32 v8, v8, v16
  v_add_f32 v9, v9, v17
  v_add_f32 v10, v10, v18
  v_add_f32 v11, v11, v19
  s_waitcnt lgkmcnt(0)
  v_add_f32 v12, v12, v20
  v_add_f32 v13, v13, v21
  v_add_f32 v14, v14, v22
  v_add_f32 v15, v15, v23
  ds_read_b128 v[16:19], v5 offset:640
  ds_read_b128 v[20:23], v5 offset:656
  s_waitcnt lgkmcnt(1)
  v_add_f32 v8, v8, v16
  v_add_f32 v9, v9, v17
  v_add_f32 v10, v10, v18
  v_add_f32 v11, v11, v19
  s_waitcnt lgkmcnt(0)
  v_add_f32 v12, v12, v20
  v_add_f32 v13, v13, v21
  v_add_f32 v14, v14, v22
  v_add_f32 v15, v15, v23
  ds_read_b128 v[16:19], v5 offset:960
  ds_read_b128 v[20:23], v5 offset:976
  s_waitcnt lgkmcnt(1)
  v_add_f32 v8, v8, v16
  v_add_f32 v9, v9, v17
  v_add_f32 v10, v10, v18
  v_add_f32 v11, v11, v19
  s_waitcnt lgkmcnt(0)
  v_add_f32 v12, v12, v20
  v_add_f32 v13, v13, v21
  v_add_f32 v14, v14, v22
  v_add_f32 v15, v15, v23
  ds_read_b128 v[16:19], v5 offset:1280
  ds_read_b128 v[20:23], v5 offset:1296
  s_waitcnt lgkmcnt(1)
  v_add_f32 v8, v8, v16
  v_add_f32 v9, v9, v17
  v_add_f32 v10, v10, v18
  v_add_f32 v11, v11, v19
  s_waitcnt lgkmcnt(0)
  v_add_f32 v12, v12, v20
  v_add_f32 v13, v13, v21
  v_add_f32 v14, v14, v22
  v_add_f32 v15, v15, v23
  ds_read_b128 v[16:19], v5 offset:1600
  ds_read_b128 v[20:23], v5 offset:1616
  s_waitcnt lgkmcnt(1)
  v_add_f32 v8, v8, v16
  v_add_f32 v9, v9, v17
  v_add_f32 v10, v10, v18
  v_add_f32 v11, v11, v19
  s_waitcnt lgkmcnt(0)
  v_add_f32 v12, v12, v20
  v_add_f32 v13, v13, v21
  v_add_f32 v14, v14, v22
  v_add_f32 v15, v15, v23
  ds_read_b128 v[16:19], v5 offset:1920
  ds_read_b128 v[20:23], v5 offset:1936
  s_waitcnt lgkmcnt(1)
  v_add_f32 v8, v8, v16
  v_add_f32 v9, v9, v17
  v_add_f32 v10, v10, v18
  v_add_f32 v11, v11, v19
  s_waitcnt lgkmcnt(0)
  v_add_f32 v12, v12, v20
  v_add_f32 v13, v13, v21
  v_add_f32 v14, v14, v22
  v_add_f32 v15, v15, v23
  ds_read_b128 v[16:19], v5 offset:2240
  ds_read_b128 v[20:23], v5 offset:2256
  s_waitcnt lgkmcnt(1)
  v_add_f32 v8, v8, v16
  v_add_f32 v9, v9, v17
  v_add_f32 v10, v10, v18
  v_add_f32 v11, v11, v19
  s_waitcnt lgkmcnt(0)
  v_add_f32 v12, v12, v20
  v_add_f32 v13, v13, v21
  v_add_f32 v14, v14, v22
  v_add_f32 v15, v15, v23
  ds_read_b128 v[16:19], v5 offset:2560
  ds_read_b128 v[20:23], v5 offset:2576
  s_waitcnt lgkmcnt(1)
  v_add_f32 v8, v8, v16
  v_add_f32 v9, v9, v17
  v_add_f32 v10, v10, v18
  v_add_f32 v11, v11, v19
  s_waitcnt lgkmcnt(0)
  v_add_f32 v12, v12, v20
  v_add_f32 v13, v13, v21
  v_add_f32 v14, v14, v22
  v_add_f32 v15, v15, v23
  ds_read_b128 v[16:19], v5 offset:2880
  ds_read_b128 v[20:23], v5 offset:2896
  s_waitcnt lgkmcnt(1)
  v_add_f32 v8, v8, v16
  v_add_f32 v9, v9, v17
  v_add_f32 v10, v10, v18
  v_add_f32 v11, v11, v19
  s_waitcnt lgkmcnt(0)
  v_add_f32 v12, v12, v20
  v_add_f32 v13, v13, v21
  v_add_f32 v14, v14, v22
  v_add_f32 v15, v15, v23
  ds_read_b128 v[16:19], v5 offset:3200
  ds_read_b128 v[20:23], v5 offset:3216
  s_waitcnt lgkmcnt(1)
  v_add_f32 v8, v8, v16
  v_add_f32 v9, v9, v17
  v_add_f32 v10, v10, v18
  v_add_f32 v11, v11, v19
  s_waitcnt lgkmcnt(0)
  v_add_f32 v12, v12, v20
  v_add_f32 v13, v13, v21
  v_add_f32 v14, v14, v22
  v_add_f32 v15, v15, v23
  ds_read_b128 v[16:19], v5 offset:3520
  ds_read_b128 v[20:23], v5 offset:3536
  s_waitcnt lgkmcnt(1)
  v_add_f32 v8, v8, v16
  v_add_f32 v9, v9, v17
  v_add_f32 v10, v10, v18
  v_add_f32 v11, v11, v19
  s_waitcnt lgkmcnt(0)
  v_add_f32 v12, v12, v20
  v_add_f32 v13, v13, v21
  v_add_f32 v14, v14, v22
  v_add_f32 v15, v15, v23
L_noy_113:
  s_mov_b64 exec, s[48:49]
  s_waitcnt vmcnt(0) lgkmcnt(0)
  v_add_f32 v6, 1.0, v34
  v_mul_f32 v40, v32, v34
  v_lshlrev_b32 v16, 16, v28
  v_and_b32 v17, s34, v28
  v_lshlrev_b32 v18, 16, v29
  v_and_b32 v19, s34, v29
  v_lshlrev_b32 v20, 16, v30
  v_and_b32 v21, s34, v30
  v_lshlrev_b32 v22, 16, v31
  v_and_b32 v23, s34, v31
  v_pk_fma_f32 v[16:17], v[16:17], v[6:7], v[40:41] op_sel_hi:[1,0,0] neg_lo:[0,0,1] neg_hi:[0,0,1]
  v_pk_fma_f32 v[18:19], v[18:19], v[6:7], v[40:41] op_sel_hi:[1,0,0] neg_lo:[0,0,1] neg_hi:[0,0,1]
  v_pk_fma_f32 v[20:21], v[20:21], v[6:7], v[40:41] op_sel_hi:[1,0,0] neg_lo:[0,0,1] neg_hi:[0,0,1]
  v_pk_fma_f32 v[22:23], v[22:23], v[6:7], v[40:41] op_sel_hi:[1,0,0] neg_lo:[0,0,1] neg_hi:[0,0,1]
  v_pk_add_f32 v[8:9], v[8:9], v[16:17]
  v_pk_add_f32 v[10:11], v[10:11], v[18:19]
  v_pk_add_f32 v[12:13], v[12:13], v[20:21]
  v_pk_add_f32 v[14:15], v[14:15], v[22:23]
  v_cvt_pk_bf16_f32 v36, v8, v9
  v_cvt_pk_bf16_f32 v37, v10, v11
  v_cvt_pk_bf16_f32 v38, v12, v13
  v_cvt_pk_bf16_f32 v39, v14, v15
  s_mov_b32 s68, s22
  s_mov_b32 s69, s23
  s_mov_b32 s70, 2621440
  s_mov_b32 s71, 0x20000
  v_mul_u32_u24 v4, 1280, v26
  v_lshl_add_u32 v4, v25, 4, v4
  s_mul_i32 s48, s5, 160
  buffer_store_dwordx4 v[36:39], v4, s[68:71], s48 offen
L_noitem_110:
  s_mov_b64 exec, s[52:53]
  s_branch L_end
L_roleQ:
  s_and_b32 s49, s33, 3
  s_lshl_b32 s37, s31, 2
  s_add_u32 s37, s37, s49
  s_lshr_b32 s49, s33, 2
  s_lshl_b32 s36, s32, 3
  s_add_u32 s36, s36, s49
  s_lshl_b32 s35, s37, 8
  s_and_b32 s48, s33, 3
  s_and_b32 s4, s2, 7
  s_lshl_b32 s4, s4, 2
  s_add_u32 s4, s4, s48
  s_lshr_b32 s5, s33, 2
  s_cmp_ge_u32 s28, 8
  s_cbranch_scc1 L_help_Q
  s_bfe_u32 s48, s2, 0x10002
  s_lshl_b32 s48, s48, 1
  s_add_u32 s48, s48, s32
  s_lshl_b32 s48, s48, 5
  s_add_u32 s48, s48, s33
  s_lshl_b32 s48, s48, 3
  s_lshl_b32 s49, s31, 10
  s_add_u32 s48, s48, s49
  s_add_u32 s6, s48, s28
  s_mul_i32 s48, s6, 1280
  v_lshlrev_b32 v3, 2, v1
  buffer_load_dword v82, v3, s[56:59], s48 offen offset:0
  buffer_load_dword v83, v3, s[56:59], s48 offen offset:256
  buffer_load_dword v84, v3, s[56:59], s48 offen offset:512
  buffer_load_dword v85, v3, s[56:59], s48 offen offset:768
  buffer_load_dword v86, v3, s[56:59], s48 offen offset:1024
  s_mov_b32 s68, s14
  s_mov_b32 s69, s15
  s_mov_b32 s70, 1280
  s_mov_b32 s71, 0x20000
  buffer_load_dword v88, v3, s[68:71], 0 offen offset:0
  buffer_load_dword v89, v3, s[68:71], 0 offen offset:256
  buffer_load_dword v90, v3, s[68:71], 0 offen offset:512
  buffer_load_dword v91, v3, s[68:71], 0 offen offset:768
  buffer_load_dword v92, v3, s[68:71], 0 offen offset:1024
  s_mov_b32 s48, s28
  s_lshl_b32 s48, s48, 12
  s_add_u32 s48, s48, 5120
  v_and_b32 v93, 31, v1
  v_lshlrev_b32 v94, 7, v93
  v_add_u32 v94, s48, v94
  v_bfe_u32 v95, v1, 1, 3
  v_lshrrev_b32 v96, 5, v1
  v_or_b32 v97, 0, v96
  v_xor_b32 v97, v97, v95
  v_lshl_add_u32 v70, v97, 4, v94
  v_or_b32 v97, 2, v96
  v_xor_b32 v97, v97, v95
  v_lshl_add_u32 v71, v97, 4, v94
  v_or_b32 v97, 4, v96
  v_xor_b32 v97, v97, v95
  v_lshl_add_u32 v72, v97, 4, v94
  v_or_b32 v97, 6, v96
  v_xor_b32 v97, v97, v95
  v_lshl_add_u32 v73, v97, 4, v94
  v_bfe_u32 v93, v1, 4, 1
  v_and_b32 v94, 3, v1
  v_lshl_or_b32 v93, v93, 2, v94
  v_lshrrev_b32 v94, 1, v93
  v_and_b32 v95, 1, v93
  v_bfe_u32 v96, v1, 2, 2
  v_lshrrev_b32 v97, 5, v1
  v_lshl_add_u32 v96, v97, 3, v96
  v_lshlrev_b32 v97, 5, v95
  v_lshl_add_u32 v97, v94, 3, v97
  v_lshl_add_u32 v74, v96, 6, v97
  v_lshlrev_b32 v97, 3, v95
  v_lshl_add_u32 v75, v96, 4, v97
  s_mov_b32 s48, s28
  s_lshl_b32 s48, s48, 5
  s_add_u32 s48, s48, s35
  s_lshl_b32 s48, s48, 4
  s_add_u32 s48, s48, 4096
  v_and_b32 v87, 31, v1
  v_lshlrev_b32 v87, 4, v87
  v_add_u32 v87, s48, v87
  v_bfe_u32 v93, v1, 4, 1
  v_and_b32 v94, 3, v1
  v_lshl_or_b32 v93, v93, 2, v94
  v_lshrrev_b32 v94, 1, v93
  v_and_b32 v95, 1, v93
  v_bfe_u32 v96, v1, 2, 2
  v_lshrrev_b32 v97, 5, v1
  s_mov_b32 s48, 151552
  v_mul_u32_u24 v98, 800, v95
  v_add_u32 v98, s48, v98
  v_lshl_add_u32 v99, v95, 2, v96
  v_mul_u32_u24 v99, 40, v99
  v_add_u32 v99, v98, v99
  v_xor_b32 v100, 1, v95
  v_lshl_add_u32 v100, v100, 4, v96
  v_mul_u32_u24 v100, 40, v100
  v_add_u32 v100, v98, v100
  v_lshl_add_u32 v78, v94, 3, v99
  v_lshl_add_u32 v80, v94, 3, v100
  v_add_u32 v79, 32, v99
  v_add_u32 v81, 32, v100
  v_mov_b32 v98, 155648
  v_cmp_eq_u32 vcc, v95, v97
  s_nop 1
  v_cndmask_b32 v78, v98, v78, vcc
  v_cndmask_b32 v80, v98, v80, vcc
  v_cmp_eq_u32 s[48:49], 0, v94
  s_nop 1
  s_and_b64 vcc, vcc, s[48:49]
  v_cndmask_b32 v79, v98, v79, vcc
  v_cndmask_b32 v81, v98, v81, vcc
  s_mov_b32 s72, s10
  s_mov_b32 s73, s11
  s_mov_b32 s74, 819200
  s_mov_b32 s75, 0x20000
  s_mul_i32 s48, s33, 200
  s_sub_u32 s49, s28, 4
  s_mul_i32 s49, s49, 50
  s_add_u32 s48, s48, s49
  v_add_u32 v76, s48, v1
  v_lshlrev_b32 v76, 7, v76
  v_mov_b32 v77, 0x7ffffff0
  s_cmp_ge_u32 s28, 4
  s_cselect_b32 s48, 50, 0
  v_cmp_gt_u32 vcc, s48, v1
  s_nop 1
  v_cndmask_b32 v76, v77, v76, vcc
  s_waitcnt lgkmcnt(0)
  s_mul_i32 s29, s30, 0x9E3779B1
  s_add_u32 s29, s29, 0x7F4A7C15
  s_waitcnt vmcnt(9)
  v_lshlrev_b32 v93, 16, v82
  v_and_b32 v94, s34, v82
  s_waitcnt vmcnt(8)
  v_lshlrev_b32 v95, 16, v83
  v_and_b32 v96, s34, v83
  s_waitcnt vmcnt(7)
  v_lshlrev_b32 v97, 16, v84
  v_and_b32 v98, s34, v84
  s_waitcnt vmcnt(6)
  v_lshlrev_b32 v99, 16, v85
  v_and_b32 v100, s34, v85
  s_waitcnt vmcnt(5)
  v_lshlrev_b32 v101, 16, v86
  v_and_b32 v102, s34, v86
  s_waitcnt vmcnt(4)
  v_lshlrev_b32 v103, 16, v88
  v_and_b32 v104, s34, v88
  s_waitcnt vmcnt(3)
  v_lshlrev_b32 v105, 16, v89
  v_and_b32 v106, s34, v89
  s_waitcnt vmcnt(2)
  v_lshlrev_b32 v107, 16, v90
  v_and_b32 v108, s34, v90
  s_waitcnt vmcnt(1)
  v_lshlrev_b32 v109, 16, v91
  v_and_b32 v110, s34, v91
  s_waitcnt vmcnt(0)
  v_lshlrev_b32 v111, 16, v92
  v_and_b32 v112, s34, v92
  v_add_f32 v113, v93, v94
  v_add_f32 v113, v113, v95
  v_add_f32 v113, v113, v96
  v_add_f32 v113, v113, v97
  v_add_f32 v113, v113, v98
  v_add_f32 v113, v113, v99
  v_add_f32 v113, v113, v100
  v_add_f32 v113, v113, v101
  v_add_f32 v113, v113, v102
  s_nop 1
  v_add_f32_dpp v113, v113, v113 row_shr:1 row_mask:0xf bank_mask:0xf bound_ctrl:0
  s_nop 1
  v_add_f32_dpp v113, v113, v113 row_shr:2 row_mask:0xf bank_mask:0xf bound_ctrl:0
  s_nop 1
  v_add_f32_dpp v113, v113, v113 row_shr:4 row_mask:0xf bank_mask:0xf bound_ctrl:0
  s_nop 1
  v_add_f32_dpp v113, v113, v113 row_shr:8 row_mask:0xf bank_mask:0xf bound_ctrl:0
  s_nop 1
  v_add_f32_dpp v113, v113, v113 row_bcast:15 row_mask:0xa bank_mask:0xf
  s_nop 1
  v_add_f32_dpp v113, v113, v113 row_bcast:31 row_mask:0xc bank_mask:0xf
  v_mul_f32 v113, 0x3acccccd, v113
  s_nop 0
  v_readlane_b32 s48, v113, 63
  s_nop 1
  v_subrev_f32 v93, s48, v93
  v_subrev_f32 v94, s48, v94
  v_subrev_f32 v95, s48, v95
  v_subrev_f32 v96, s48, v96
  v_subrev_f32 v97, s48, v97
  v_subrev_f32 v98, s48, v98
  v_subrev_f32 v99, s48, v99
  v_subrev_f32 v100, s48, v100
  v_subrev_f32 v101, s48, v101
  v_subrev_f32 v102, s48, v102
  v_mul_f32 v114, v93, v93
  v_mul_f32 v115, v93, v103
  v_fmac_f32 v114, v94, v94
  v_fmac_f32 v115, v94, v104
  v_fmac_f32 v114, v95, v95
  v_fmac_f32 v115, v95, v105
  v_fmac_f32 v114, v96, v96
  v_fmac_f32 v115, v96, v106
  v_fmac_f32 v114, v97, v97
  v_fmac_f32 v115, v97, v107
  v_fmac_f32 v114, v98, v98
  v_fmac_f32 v115, v98, v108
  v_fmac_f32 v114, v99, v99
  v_fmac_f32 v115, v99, v109
  v_fmac_f32 v114, v100, v100
  v_fmac_f32 v115, v100, v110
  v_fmac_f32 v114, v101, v101
  v_fmac_f32 v115, v101, v111
  v_fmac_f32 v114, v102, v102
  v_fmac_f32 v115, v102, v112
  s_nop 0
  v_add_f32_dpp v114, v114, v114 row_shr:1 row_mask:0xf bank_mask:0xf bound_ctrl:0
  v_add_f32_dpp v115, v115, v115 row_shr:1 row_mask:0xf bank_mask:0xf bound_ctrl:0
  s_nop 0
  v_add_f32_dpp v114, v114, v114 row_shr:2 row_mask:0xf bank_mask:0xf bound_ctrl:0
  v_add_f32_dpp v115, v115, v115 row_shr:2 row_mask:0xf bank_mask:0xf bound_ctrl:0
  s_nop 0
  v_add_f32_dpp v114, v114, v114 row_shr:4 row_mask:0xf bank_mask:0xf bound_ctrl:0
  v_add_f32_dpp v115, v115, v115 row_shr:4 row_mask:0xf bank_mask:0xf bound_ctrl:0
  s_nop 0
  v_add_f32_dpp v114, v114, v114 row_shr:8 row_mask:0xf bank_mask:0xf bound_ctrl:0
  v_add_f32_dpp v115, v115, v115 row_shr:8 row_mask:0xf bank_mask:0xf bound_ctrl:0
  s_nop 0
  v_add_f32_dpp v114, v114, v114 row_bcast:15 row_mask:0xa bank_mask:0xf
  v_add_f32_dpp v115, v115, v115 row_bcast:15 row_mask:0xa bank_mask:0xf
  s_nop 0
  v_add_f32_dpp v114, v114, v114 row_bcast:31 row_mask:0xc bank_mask:0xf
  v_add_f32_dpp v115, v115, v115 row_bcast:31 row_mask:0xc bank_mask:0xf
  v_mul_f32 v114, 0x3acccccd, v114
  v_add_f32 v114, 0x3727c5ac, v114
  v_rsq_f32 v114, v114
  s_nop 0
  v_mul_f32 v115, v115, v114
  v_readlane_b32 s49, v114, 63
  v_readlane_b32 s50, v115, 63
  v_mov_b32 v120, s48
  v_mov_b32 v121, s29
  v_mov_b32 v122, s49
  v_mov_b32 v123, s29
  s_lshl_b32 s51, s6, 4
  s_add_u32 s51, s51, 4096
  s_ashr_i32 s52, s50, 31
  s_or_b32 s52, s52, 0x80000000
  s_xor_b32 s52, s52, s50
  s_and_b32 s52, s52, 0xfffff800
  s_sub_u32 s53, 2047, s6
  s_or_b32 s52, s52, s53
  s_lshl_b32 s53, s28, 2
  s_add_u32 s53, s53, 156672
  v_mov_b32 v113, s52
  v_mov_b32 v114, s53
  v_mov_b32 v116, 0
  s_mov_b64 s[54:55], exec
  s_mov_b64 exec, 1
  buffer_store_dwordx4 v[120:123], v116, s[64:67], s51 offen sc1
  ds_write_b32 v114, v113
  s_mov_b64 exec, s[54:55]
  s_waitcnt lgkmcnt(0)
  v_mov_b32 v4, 0
  v_mov_b32 v5, 0
  v_mov_b32 v6, 0
  v_mov_b32 v7, 0
  v_mov_b32 v8, 0
  v_mov_b32 v9, 0
  v_mov_b32 v10, 0
  v_mov_b32 v11, 0
  v_mov_b32 v12, 0
  v_mov_b32 v13, 0
  v_mov_b32 v14, 0
  v_mov_b32 v15, 0
  v_mov_b32 v16, 0
  v_mov_b32 v17, 0
  v_mov_b32 v18, 0
  v_mov_b32 v19, 0
  v_mov_b32 v20, 0
  v_mov_b32 v21, 0
  v_mov_b32 v22, 0
  v_mov_b32 v23, 0
  v_mov_b32 v24, 0
  v_mov_b32 v25, 0
  v_mov_b32 v26, 0
  v_mov_b32 v27, 0
  v_mov_b32 v28, 0
  v_mov_b32 v29, 0
  v_mov_b32 v30, 0
  v_mov_b32 v31, 0
  v_mov_b32 v32, 0
  v_mov_b32 v33, 0
  v_mov_b32 v34, 0
  v_mov_b32 v35, 0
  v_mov_b32 v64, 0
  v_mov_b32 v65, 0
  v_mov_b32 v66, 0
  v_mov_b32 v67, 0
  v_mov_b32 v68, 0
  v_mov_b32 v69, 0
  s_waitcnt lgkmcnt(0)
  s_cmp_lt_u32 s28, 4
  s_cselect_b32 s7, s28, 9
  v_bfe_u32 v44, v1, 4, 1
  v_bfe_u32 v45, v1, 1, 1
  v_or_b32 v44, v44, v45
  v_cmp_eq_u32 s[12:13], 0, v44
  v_mov_b32 v69, 151552
  s_nop 0
  v_cndmask_b32 v75, v69, v75, s[12:13]
  s_mov_b32 s38, 0
  s_mov_b32 s41, 0
  s_barrier
  ds_read_b128 v[88:91], v70
  ds_read_b64_tr_b16 v[92:93], v74 offset:0
  ds_read_b64_tr_b16 v[94:95], v74 offset:256
  ds_read_b64_tr_b16 v[96:97], v75 offset:4096
  ds_read_b64_tr_b16 v[98:99], v75 offset:4160
  ds_read_b128 v[100:103], v71
  ds_read_b64_tr_b16 v[104:105], v74 offset:1024
  ds_read_b64_tr_b16 v[106:107], v74 offset:1280
  ds_read_b64_tr_b16 v[108:109], v75 offset:4352
  ds_read_b64_tr_b16 v[110:111], v75 offset:4416
L_cloop_Q:
  s_waitcnt lgkmcnt(5)
  s_cmp_lg_u32 s7, 0
  s_cbranch_scc1 L_plain_114
  v_mfma_f32_32x32x16_bf16 v[4:19], v[92:95], v[88:91], v[4:19]
  ds_read_b128 v[112:115], v72
  ds_read_b64_tr_b16 v[116:117], v74 offset:2048
  ds_read_b64_tr_b16 v[118:119], v74 offset:2304
  v_and_b32 v36, s34, v92
  v_lshlrev_b32 v37, 16, v92
  v_and_b32 v38, s34, v93
  v_lshlrev_b32 v39, 16, v93
  v_add_f32 v64, v64, v36
  v_add_f32 v65, v65, v37
  v_add_f32 v64, v64, v38
  v_add_f32 v65, v65, v39
  v_and_b32 v36, s34, v94
  v_lshlrev_b32 v37, 16, v94
  v_and_b32 v38, s34, v95
  v_lshlrev_b32 v39, 16, v95
  v_add_f32 v64, v64, v36
  v_add_f32 v65, v65, v37
  v_add_f32 v64, v64, v38
  v_add_f32 v65, v65, v39
  v_mfma_f32_32x32x16_bf16 v[20:35], v[96:99], v[88:91], v[20:35]
  ds_read_b64_tr_b16 v[120:121], v75 offset:4608
  ds_read_b64_tr_b16 v[122:123], v75 offset:4672
  v_and_b32 v36, s34, v96
  v_lshlrev_b32 v37, 16, v96
  v_and_b32 v38, s34, v97
  v_lshlrev_b32 v39, 16, v97
  v_add_f32 v66, v66, v36
  v_add_f32 v67, v67, v37
  v_add_f32 v66, v66, v38
  v_add_f32 v67, v67, v39
  v_and_b32 v36, s34, v98
  v_lshlrev_b32 v37, 16, v98
  v_and_b32 v38, s34, v99
  v_lshlrev_b32 v39, 16, v99
  v_add_f32 v66, v66, v36
  v_add_f32 v67, v67, v37
  v_add_f32 v66, v66, v38
  v_add_f32 v67, v67, v39
  s_branch L_stepdone_115
L_plain_114:
  v_mfma_f32_32x32x16_bf16 v[4:19], v[92:95], v[88:91], v[4:19]
  ds_read_b128 v[112:115], v72
  ds_read_b64_tr_b16 v[116:117], v74 offset:2048
  ds_read_b64_tr_b16 v[118:119], v74 offset:2304
  v_mfma_f32_32x32x16_bf16 v[20:35], v[96:99], v[88:91], v[20:35]
  ds_read_b64_tr_b16 v[120:121], v75 offset:4608
  ds_read_b64_tr_b16 v[122:123], v75 offset:4672
L_stepdone_115:
  s_waitcnt lgkmcnt(5)
  s_cmp_lg_u32 s7, 1
  s_cbranch_scc1 L_plain_116
  v_mfma_f32_32x32x16_bf16 v[4:19], v[104:107], v[100:103], v[4:19]
  ds_read_b128 v[124:127], v73
  ds_read_b64_tr_b16 v[128:129], v74 offset:3072
  ds_read_b64_tr_b16 v[130:131], v74 offset:3328
  v_and_b32 v36, s34, v104
  v_lshlrev_b32 v37, 16, v104
  v_and_b32 v38, s34, v105
  v_lshlrev_b32 v39, 16, v105
  v_add_f32 v64, v64, v36
  v_add_f32 v65, v65, v37
  v_add_f32 v64, v64, v38
  v_add_f32 v65, v65, v39
  v_and_b32 v36, s34, v106
  v_lshlrev_b32 v37, 16, v106
  v_and_b32 v38, s34, v107
  v_lshlrev_b32 v39, 16, v107
  v_add_f32 v64, v64, v36
  v_add_f32 v65, v65, v37
  v_add_f32 v64, v64, v38
  v_add_f32 v65, v65, v39
  v_mfma_f32_32x32x16_bf16 v[20:35], v[108:111], v[100:103], v[20:35]
  ds_read_b64_tr_b16 v[132:133], v75 offset:4864
  ds_read_b64_tr_b16 v[134:135], v75 offset:4928
  v_and_b32 v36, s34, v108
  v_lshlrev_b32 v37, 16, v108
  v_and_b32 v38, s34, v109
  v_lshlrev_b32 v39, 16, v109
  v_add_f32 v66, v66, v36
  v_add_f32 v67, v67, v37
  v_add_f32 v66, v66, v38
  v_add_f32 v67, v67, v39
  v_and_b32 v36, s34, v110
  v_lshlrev_b32 v37, 16, v110
  v_and_b32 v38, s34, v111
  v_lshlrev_b32 v39, 16, v111
  v_add_f32 v66, v66, v36
  v_add_f32 v67, v67, v37
  v_add_f32 v66, v66, v38
  v_add_f32 v67, v67, v39
  s_branch L_stepdone_117
L_plain_116:
  v_mfma_f32_32x32x16_bf16 v[4:19], v[104:107], v[100:103], v[4:19]
  ds_read_b128 v[124:127], v73
  ds_read_b64_tr_b16 v[128:129], v74 offset:3072
  ds_read_b64_tr_b16 v[130:131], v74 offset:3328
  v_mfma_f32_32x32x16_bf16 v[20:35], v[108:111], v[100:103], v[20:35]
  ds_read_b64_tr_b16 v[132:133], v75 offset:4864
  ds_read_b64_tr_b16 v[134:135], v75 offset:4928
L_stepdone_117:
  s_cmp_eq_u32 s38, 9
  s_cbranch_scc1 L_last_118
  s_cmp_lg_u32 s38, 6
  s_cbranch_scc1 L_nostat_119
  buffer_load_dwordx4 v[60:63], v87, s[64:67], 0 offen sc1
L_nostat_119:
  s_add_u32 s41, s41, 37888
  s_cmp_eq_u32 s41, 151552
  s_cselect_b32 s41, 0, s41
  s_mov_b32 s42, 37888
  s_cselect_b32 s42, 4294853632, s42
  v_add_u32 v70, s42, v70
  v_add_u32 v71, s42, v71
  v_add_u32 v72, s42, v72
  v_add_u32 v73, s42, v73
  v_add_u32 v74, s42, v74
  v_add_u32 v75, s42, v75
  v_cndmask_b32 v75, v69, v75, s[12:13]
  s_barrier
  s_waitcnt lgkmcnt(5)
  s_cmp_lg_u32 s7, 2
  s_cbranch_scc1 L_plain_120
  v_mfma_f32_32x32x16_bf16 v[4:19], v[116:119], v[112:115], v[4:19]
  ds_read_b128 v[88:91], v70
  ds_read_b64_tr_b16 v[92:93], v74 offset:0
  ds_read_b64_tr_b16 v[94:95], v74 offset:256
  v_and_b32 v36, s34, v116
  v_lshlrev_b32 v37, 16, v116
  v_and_b32 v38, s34, v117
  v_lshlrev_b32 v39, 16, v117
  v_add_f32 v64, v64, v36
  v_add_f32 v65, v65, v37
  v_add_f32 v64, v64, v38
  v_add_f32 v65, v65, v39
  v_and_b32 v36, s34, v118
  v_lshlrev_b32 v37, 16, v118
  v_and_b32 v38, s34, v119
  v_lshlrev_b32 v39, 16, v119
  v_add_f32 v64, v64, v36
  v_add_f32 v65, v65, v37
  v_add_f32 v64, v64, v38
  v_add_f32 v65, v65, v39
  v_mfma_f32_32x32x16_bf16 v[20:35], v[120:123], v[112:115], v[20:35]
  ds_read_b64_tr_b16 v[96:97], v75 offset:4096
  ds_read_b64_tr_b16 v[98:99], v75 offset:4160
  v_and_b32 v36, s34, v120
  v_lshlrev_b32 v37, 16, v120
  v_and_b32 v38, s34, v121
  v_lshlrev_b32 v39, 16, v121
  v_add_f32 v66, v66, v36
  v_add_f32 v67, v67, v37
  v_add_f32 v66, v66, v38
  v_add_f32 v67, v67, v39
  v_and_b32 v36, s34, v122
  v_lshlrev_b32 v37, 16, v122
  v_and_b32 v38, s34, v123
  v_lshlrev_b32 v39, 16, v123
  v_add_f32 v66, v66, v36
  v_add_f32 v67, v67, v37
  v_add_f32 v66, v66, v38
  v_add_f32 v67, v67, v39
  s_branch L_stepdone_121
L_plain_120:
  v_mfma_f32_32x32x16_bf16 v[4:19], v[116:119], v[112:115], v[4:19]
  ds_read_b128 v[88:91], v70
  ds_read_b64_tr_b16 v[92:93], v74 offset:0
  ds_read_b64_tr_b16 v[94:95], v74 offset:256
  v_mfma_f32_32x32x16_bf16 v[20:35], v[120:123], v[112:115], v[20:35]
  ds_read_b64_tr_b16 v[96:97], v75 offset:4096
  ds_read_b64_tr_b16 v[98:99], v75 offset:4160
L_stepdone_121:
  s_waitcnt lgkmcnt(5)
  s_cmp_lg_u32 s7, 3
  s_cbranch_scc1 L_plain_122
  v_mfma_f32_32x32x16_bf16 v[4:19], v[128:131], v[124:127], v[4:19]
  ds_read_b128 v[100:103], v71
  ds_read_b64_tr_b16 v[104:105], v74 offset:1024
  ds_read_b64_tr_b16 v[106:107], v74 offset:1280
  v_and_b32 v36, s34, v128
  v_lshlrev_b32 v37, 16, v128
  v_and_b32 v38, s34, v129
  v_lshlrev_b32 v39, 16, v129
  v_add_f32 v64, v64, v36
  v_add_f32 v65, v65, v37
  v_add_f32 v64, v64, v38
  v_add_f32 v65, v65, v39
  v_and_b32 v36, s34, v130
  v_lshlrev_b32 v37, 16, v130
  v_and_b32 v38, s34, v131
  v_lshlrev_b32 v39, 16, v131
  v_add_f32 v64, v64, v36
  v_add_f32 v65, v65, v37
  v_add_f32 v64, v64, v38
  v_add_f32 v65, v65, v39
  v_mfma_f32_32x32x16_bf16 v[20:35], v[132:135], v[124:127], v[20:35]
  ds_read_b64_tr_b16 v[108:109], v75 offset:4352
  ds_read_b64_tr_b16 v[110:111], v75 offset:4416
  v_and_b32 v36, s34, v132
  v_lshlrev_b32 v37, 16, v132
  v_and_b32 v38, s34, v133
  v_lshlrev_b32 v39, 16, v133
  v_add_f32 v66, v66, v36
  v_add_f32 v67, v67, v37
  v_add_f32 v66, v66, v38
  v_add_f32 v67, v67, v39
  v_and_b32 v36, s34, v134
  v_lshlrev_b32 v37, 16, v134
  v_and_b32 v38, s34, v135
  v_lshlrev_b32 v39, 16, v135
  v_add_f32 v66, v66, v36
  v_add_f32 v67, v67, v37
  v_add_f32 v66, v66, v38
  v_add_f32 v67, v67, v39
  s_branch L_stepdone_123
L_plain_122:
  v_mfma_f32_32x32x16_bf16 v[4:19], v[128:131], v[124:127], v[4:19]
  ds_read_b128 v[100:103], v71
  ds_read_b64_tr_b16 v[104:105], v74 offset:1024
  ds_read_b64_tr_b16 v[106:107], v74 offset:1280
  v_mfma_f32_32x32x16_bf16 v[20:35], v[132:135], v[124:127], v[20:35]
  ds_read_b64_tr_b16 v[108:109], v75 offset:4352
  ds_read_b64_tr_b16 v[110:111], v75 offset:4416
L_stepdone_123:
  s_add_u32 s38, s38, 1
  s_branch L_cloop_Q
L_last_118:
  s_waitcnt lgkmcnt(5)
  s_cmp_lg_u32 s7, 2
  s_cbranch_scc1 L_plain_124
  v_mfma_f32_32x32x16_bf16 v[4:19], v[116:119], v[112:115], v[4:19]
  v_and_b32 v36, s34, v116
  v_lshlrev_b32 v37, 16, v116
  v_and_b32 v38, s34, v117
  v_lshlrev_b32 v39, 16, v117
  v_add_f32 v64, v64, v36
  v_add_f32 v65, v65, v37
  v_add_f32 v64, v64, v38
  v_add_f32 v65, v65, v39
  v_and_b32 v36, s34, v118
  v_lshlrev_b32 v37, 16, v118
  v_and_b32 v38, s34, v119
  v_lshlrev_b32 v39, 16, v119
  v_add_f32 v64, v64, v36
  v_add_f32 v65, v65, v37
  v_add_f32 v64, v64, v38
  v_add_f32 v65, v65, v39
  v_mfma_f32_32x32x16_bf16 v[20:35], v[120:123], v[112:115], v[20:35]
  v_and_b32 v36, s34, v120
  v_lshlrev_b32 v37, 16, v120
  v_and_b32 v38, s34, v121
  v_lshlrev_b32 v39, 16, v121
  v_add_f32 v66, v66, v36
  v_add_f32 v67, v67, v37
  v_add_f32 v66, v66, v38
  v_add_f32 v67, v67, v39
  v_and_b32 v36, s34, v122
  v_lshlrev_b32 v37, 16, v122
  v_and_b32 v38, s34, v123
  v_lshlrev_b32 v39, 16, v123
  v_add_f32 v66, v66, v36
  v_add_f32 v67, v67, v37
  v_add_f32 v66, v66, v38
  v_add_f32 v67, v67, v39
  s_branch L_stepdone_125
L_plain_124:
  v_mfma_f32_32x32x16_bf16 v[4:19], v[116:119], v[112:115], v[4:19]
  v_mfma_f32_32x32x16_bf16 v[20:35], v[120:123], v[112:115], v[20:35]
L_stepdone_125:
  s_waitcnt lgkmcnt(0)
  s_cmp_lg_u32 s7, 3
  s_cbranch_scc1 L_plain_126
  v_mfma_f32_32x32x16_bf16 v[4:19], v[128:131], v[124:127], v[4:19]
  v_and_b32 v36, s34, v128
  v_lshlrev_b32 v37, 16, v128
  v_and_b32 v38, s34, v129
  v_lshlrev_b32 v39, 16, v129
  v_add_f32 v64, v64, v36
  v_add_f32 v65, v65, v37
  v_add_f32 v64, v64, v38
  v_add_f32 v65, v65, v39
  v_and_b32 v36, s34, v130
  v_lshlrev_b32 v37, 16, v130
  v_and_b32 v38, s34, v131
  v_lshlrev_b32 v39, 16, v131
  v_add_f32 v64, v64, v36
  v_add_f32 v65, v65, v37
  v_add_f32 v64, v64, v38
  v_add_f32 v65, v65, v39
  v_mfma_f32_32x32x16_bf16 v[20:35], v[132:135], v[124:127], v[20:35]
  v_and_b32 v36, s34, v132
  v_lshlrev_b32 v37, 16, v132
  v_and_b32 v38, s34, v133
  v_lshlrev_b32 v39, 16, v133
  v_add_f32 v66, v66, v36
  v_add_f32 v67, v67, v37
  v_add_f32 v66, v66, v38
  v_add_f32 v67, v67, v39
  v_and_b32 v36, s34, v134
  v_lshlrev_b32 v37, 16, v134
  v_and_b32 v38, s34, v135
  v_lshlrev_b32 v39, 16, v135
  v_add_f32 v66, v66, v36
  v_add_f32 v67, v67, v37
  v_add_f32 v66, v66, v38
  v_add_f32 v67, v67, v39
  s_branch L_stepdone_127
L_plain_126:
  v_mfma_f32_32x32x16_bf16 v[4:19], v[128:131], v[124:127], v[4:19]
  v_mfma_f32_32x32x16_bf16 v[20:35], v[132:135], v[124:127], v[20:35]
L_stepdone_127:
  s_waitcnt vmcnt(0)
  s_cmp_ge_u32 s28, 4
  s_cbranch_scc1 L_nocsw_128
  v_and_b32 v88, 31, v1
  v_lshlrev_b32 v88, 4, v88
  s_and_b32 s48, s28, 3
  s_lshl_b32 s48, s48, 1
  s_add_u32 s48, s48, 153600
  v_add_u32 v88, s48, v88
  v_add_f32 v64, v64, v65
  v_mov_b32 v89, v64
  s_nop 1
  v_permlane32_swap_b32 v89, v64
  v_add_f32 v64, v64, v89
  v_cvt_pk_bf16_f32 v89, v64, v64
  v_lshlrev_b32 v90, 16, v89
  v_sub_f32 v90, v64, v90
  v_cvt_pk_bf16_f32 v90, v90, v90
  ds_write_b16 v88, v89 offset:0
  ds_write_b16 v88, v90 offset:8
  v_add_f32 v66, v66, v67
  v_mov_b32 v89, v66
  s_nop 1
  v_permlane32_swap_b32 v89, v66
  v_add_f32 v66, v66, v89
  v_cvt_pk_bf16_f32 v89, v66, v66
  v_lshlrev_b32 v90, 16, v89
  v_sub_f32 v90, v66, v90
  v_cvt_pk_bf16_f32 v90, v90, v90
  ds_write_b16 v88, v89 offset:512
  ds_write_b16 v88, v90 offset:520
  s_waitcnt lgkmcnt(0)
L_nocsw_128:
  ds_read_b64_tr_b16 v[36:37], v78 offset:0
  ds_read_b64_tr_b16 v[38:39], v78 offset:160
  ds_read_b64_tr_b16 v[40:41], v78 offset:320
  ds_read_b64_tr_b16 v[42:43], v78 offset:480
  ds_read_b64_tr_b16 v[44:45], v80
  v_mov_b32 v46, 0
  v_mov_b32 v47, 0
  ds_read_b64_tr_b16 v[48:49], v79 offset:0
  ds_read_b64_tr_b16 v[50:51], v79 offset:160
  ds_read_b64_tr_b16 v[52:53], v79 offset:320
  ds_read_b64_tr_b16 v[54:55], v79 offset:480
  ds_read_b64_tr_b16 v[56:57], v81
  v_mov_b32 v58, 0
  v_mov_b32 v59, 0
  s_barrier
  v_and_b32 v82, 31, v1
  v_lshlrev_b32 v82, 4, v82
  v_add_u32 v82, 153600, v82
  ds_read_b128 v[88:91], v82 offset:0
  ds_read_b128 v[92:95], v82 offset:512
  s_mov_b32 s50, 0
L_stat_again_129:
  v_cmp_ne_u32 vcc, s29, v61
  v_cmp_ne_u32 s[48:49], s29, v63
  s_nop 1
  s_or_b64 vcc, vcc, s[48:49]
  s_cbranch_vccz L_stat_ok_130
  s_add_u32 s50, s50, 1
  s_cmp_gt_u32 s50, 40000
  s_cbranch_scc1 L_stat_ok_130
  buffer_load_dwordx4 v[60:63], v87, s[64:67], 0 offen sc1
  s_waitcnt vmcnt(0)
  s_branch L_stat_again_129
L_stat_ok_130:
  v_sub_f32 v83, 0, v60
  v_cvt_pk_bf16_f32 v84, v83, v83
  v_lshlrev_b32 v85, 16, v84
  v_sub_f32 v85, v83, v85
  v_cvt_pk_bf16_f32 v85, v85, v85
  v_cmp_gt_u32 vcc, 32, v1
  s_nop 1
  v_cndmask_b32 v96, v85, v84, vcc
  v_cndmask_b32 v98, 0, v84, vcc
  v_mov_b32 v97, v96
  v_mov_b32 v99, v98
  s_waitcnt lgkmcnt(1)
  s_nop 0
  v_mfma_f32_32x32x16_bf16 v[4:19], v[88:91], v[96:99], v[4:19]
  s_waitcnt lgkmcnt(0)
  v_mfma_f32_32x32x16_bf16 v[20:35], v[92:95], v[96:99], v[20:35]
  s_nop 9
  v_cvt_pk_bf16_f32 v64, v4, v5
  v_cvt_pk_bf16_f32 v65, v6, v7
  v_cvt_pk_bf16_f32 v66, v8, v9
  v_cvt_pk_bf16_f32 v67, v10, v11
  v_cvt_pk_bf16_f32 v68, v12, v13
  v_cvt_pk_bf16_f32 v69, v14, v15
  v_cvt_pk_bf16_f32 v70, v16, v17
  v_cvt_pk_bf16_f32 v71, v18, v19
  v_cvt_pk_bf16_f32 v72, v20, v21
  v_cvt_pk_bf16_f32 v73, v22, v23
  v_mov_b32 v74, 0
  v_mov_b32 v75, 0
  v_mfma_f32_32x32x16_bf16 v[104:119], v[48:51], v[64:67], 0
  v_mfma_f32_32x32x16_bf16 v[88:103], v[36:39], v[64:67], 0
  v_mfma_f32_32x32x16_bf16 v[104:119], v[52:55], v[68:71], v[104:119]
  v_mfma_f32_32x32x16_bf16 v[88:103], v[40:43], v[68:71], v[88:103]
  v_mfma_f32_32x32x16_bf16 v[104:119], v[56:59], v[72:75], v[104:119]
  v_mfma_f32_32x32x16_bf16 v[88:103], v[44:47], v[72:75], v[88:103]
  v_mul_f32 v124, 0x3fb8aa3b, v62
  s_nop 10
  v_max3_f32 v120, v88, v89, v90
  v_max3_f32 v121, v91, v92, v93
  v_max3_f32 v120, v120, v94, v95
  v_max3_f32 v121, v121, v96, v97
  v_max3_f32 v120, v120, v98, v99
  v_max3_f32 v121, v121, v100, v101
  v_max3_f32 v120, v120, v102, v103
  v_max3_f32 v121, v121, v104, v105
  v_max3_f32 v120, v120, v106, v107
  v_max_f32 v120, v120, v121
  v_mul_f32 v120, v120, v124
  v_pk_fma_f32 v[64:65], v[88:89], v[124:125], v[120:121] op_sel_hi:[1,0,0] neg_lo:[0,0,1] neg_hi:[0,0,1]
  v_pk_fma_f32 v[66:67], v[90:91], v[124:125], v[120:121] op_sel_hi:[1,0,0] neg_lo:[0,0,1] neg_hi:[0,0,1]
  v_pk_fma_f32 v[68:69], v[92:93], v[124:125], v[120:121] op_sel_hi:[1,0,0] neg_lo:[0,0,1] neg_hi:[0,0,1]
  v_pk_fma_f32 v[70:71], v[94:95], v[124:125], v[120:121] op_sel_hi:[1,0,0] neg_lo:[0,0,1] neg_hi:[0,0,1]
  v_pk_fma_f32 v[72:73], v[96:97], v[124:125], v[120:121] op_sel_hi:[1,0,0] neg_lo:[0,0,1] neg_hi:[0,0,1]
  v_pk_fma_f32 v[74:75], v[98:99], v[124:125], v[120:121] op_sel_hi:[1,0,0] neg_lo:[0,0,1] neg_hi:[0,0,1]
  v_pk_fma_f32 v[76:77], v[100:101], v[124:125], v[120:121] op_sel_hi:[1,0,0] neg_lo:[0,0,1] neg_hi:[0,0,1]
  v_pk_fma_f32 v[78:79], v[102:103], v[124:125], v[120:121] op_sel_hi:[1,0,0] neg_lo:[0,0,1] neg_hi:[0,0,1]
  v_pk_fma_f32 v[80:81], v[104:105], v[124:125], v[120:121] op_sel_hi:[1,0,0] neg_lo:[0,0,1] neg_hi:[0,0,1]
  v_pk_fma_f32 v[82:83], v[106:107], v[124:125], v[120:121] op_sel_hi:[1,0,0] neg_lo:[0,0,1] neg_hi:[0,0,1]
  v_exp_f32 v64, v64
  v_exp_f32 v65, v65
  v_exp_f32 v66, v66
  v_exp_f32 v67, v67
  v_exp_f32 v68, v68
  v_exp_f32 v69, v69
  v_exp_f32 v70, v70
  v_exp_f32 v71, v71
  v_exp_f32 v72, v72
  v_exp_f32 v73, v73
  v_exp_f32 v74, v74
  v_exp_f32 v75, v75
  v_exp_f32 v76, v76
  v_exp_f32 v77, v77
  v_exp_f32 v78, v78
  v_exp_f32 v79, v79
  v_exp_f32 v80, v80
  v_exp_f32 v81, v81
  v_exp_f32 v82, v82
  v_exp_f32 v83, v83
  v_rcp_f32 v4, v64
  v_rcp_f32 v5, v65
  v_rcp_f32 v6, v66
  v_rcp_f32 v7, v67
  v_rcp_f32 v8, v68
  v_rcp_f32 v9, v69
  v_rcp_f32 v10, v70
  v_rcp_f32 v11, v71
  v_rcp_f32 v12, v72
  v_rcp_f32 v13, v73
  v_rcp_f32 v14, v74
  v_rcp_f32 v15, v75
  v_rcp_f32 v16, v76
  v_rcp_f32 v17, v77
  v_rcp_f32 v18, v78
  v_rcp_f32 v19, v79
  v_rcp_f32 v20, v80
  v_rcp_f32 v21, v81
  v_rcp_f32 v22, v82
  v_rcp_f32 v23, v83
  v_pk_add_f32 v[126:127], v[64:65], v[66:67]
  v_pk_add_f32 v[126:127], v[126:127], v[68:69]
  v_pk_add_f32 v[126:127], v[126:127], v[70:71]
  v_pk_add_f32 v[126:127], v[126:127], v[72:73]
  v_pk_add_f32 v[126:127], v[126:127], v[74:75]
  v_pk_add_f32 v[126:127], v[126:127], v[76:77]
  v_pk_add_f32 v[126:127], v[126:127], v[78:79]
  v_pk_add_f32 v[126:127], v[126:127], v[80:81]
  v_pk_add_f32 v[126:127], v[126:127], v[82:83]
  v_add_f32 v126, v126, v127
  v_pk_add_f32 v[128:129], v[4:5], v[6:7]
  v_pk_add_f32 v[128:129], v[128:129], v[8:9]
  v_pk_add_f32 v[128:129], v[128:129], v[10:11]
  v_pk_add_f32 v[128:129], v[128:129], v[12:13]
  v_pk_add_f32 v[128:129], v[128:129], v[14:15]
  v_pk_add_f32 v[128:129], v[128:129], v[16:17]
  v_pk_add_f32 v[128:129], v[128:129], v[18:19]
  v_pk_add_f32 v[128:129], v[128:129], v[20:21]
  v_pk_add_f32 v[128:129], v[128:129], v[22:23]
  v_add_f32 v128, v128, v129
  v_cmp_ngt_f32 vcc, 0x71800000, v128
  s_nop 0
  s_cbranch_vccz L_recip_ok_131
  v_min3_f32 v122, v88, v89, v90
  v_min3_f32 v123, v91, v92, v93
  v_min3_f32 v122, v122, v94, v95
  v_min3_f32 v123, v123, v96, v97
  v_min3_f32 v122, v122, v98, v99
  v_min3_f32 v123, v123, v100, v101
  v_min3_f32 v122, v122, v102, v103
  v_min3_f32 v123, v123, v104, v105
  v_min3_f32 v122, v122, v106, v107
  v_min_f32 v122, v122, v123
  v_mul_f32 v122, v122, v124
  v_pk_fma_f32 v[4:5], v[88:89], v[124:125], v[122:123] op_sel_hi:[1,0,0] neg_lo:[1,0,0] neg_hi:[1,0,0]
  v_pk_fma_f32 v[6:7], v[90:91], v[124:125], v[122:123] op_sel_hi:[1,0,0] neg_lo:[1,0,0] neg_hi:[1,0,0]
  v_pk_fma_f32 v[8:9], v[92:93], v[124:125], v[122:123] op_sel_hi:[1,0,0] neg_lo:[1,0,0] neg_hi:[1,0,0]
  v_pk_fma_f32 v[10:11], v[94:95], v[124:125], v[122:123] op_sel_hi:[1,0,0] neg_lo:[1,0,0] neg_hi:[1,0,0]
  v_pk_fma_f32 v[12:13], v[96:97], v[124:125], v[122:123] op_sel_hi:[1,0,0] neg_lo:[1,0,0] neg_hi:[1,0,0]
  v_pk_fma_f32 v[14:15], v[98:99], v[124:125], v[122:123] op_sel_hi:[1,0,0] neg_lo:[1,0,0] neg_hi:[1,0,0]
  v_pk_fma_f32 v[16:17], v[100:101], v[124:125], v[122:123] op_sel_hi:[1,0,0] neg_lo:[1,0,0] neg_hi:[1,0,0]
  v_pk_fma_f32 v[18:19], v[102:103], v[124:125], v[122:123] op_sel_hi:[1,0,0] neg_lo:[1,0,0] neg_hi:[1,0,0]
  v_pk_fma_f32 v[20:21], v[104:105], v[124:125], v[122:123] op_sel_hi:[1,0,0] neg_lo:[1,0,0] neg_hi:[1,0,0]
  v_pk_fma_f32 v[22:23], v[106:107], v[124:125], v[122:123] op_sel_hi:[1,0,0] neg_lo:[1,0,0] neg_hi:[1,0,0]
  v_exp_f32 v4, v4
  v_exp_f32 v5, v5
  v_exp_f32 v6, v6
  v_exp_f32 v7, v7
  v_exp_f32 v8, v8
  v_exp_f32 v9, v9
  v_exp_f32 v10, v10
  v_exp_f32 v11, v11
  v_exp_f32 v12, v12
  v_exp_f32 v13, v13
  v_exp_f32 v14, v14
  v_exp_f32 v15, v15
  v_exp_f32 v16, v16
  v_exp_f32 v17, v17
  v_exp_f32 v18, v18
  v_exp_f32 v19, v19
  v_exp_f32 v20, v20
  v_exp_f32 v21, v21
  v_exp_f32 v22, v22
  v_exp_f32 v23, v23
  v_pk_add_f32 v[128:129], v[4:5], v[6:7]
  v_pk_add_f32 v[128:129], v[128:129], v[8:9]
  v_pk_add_f32 v[128:129], v[128:129], v[10:11]
  v_pk_add_f32 v[128:129], v[128:129], v[12:13]
  v_pk_add_f32 v[128:129], v[128:129], v[14:15]
  v_pk_add_f32 v[128:129], v[128:129], v[16:17]
  v_pk_add_f32 v[128:129], v[128:129], v[18:19]
  v_pk_add_f32 v[128:129], v[128:129], v[20:21]
  v_pk_add_f32 v[128:129], v[128:129], v[22:23]
  v_add_f32 v128, v128, v129
L_recip_ok_131:
  v_rcp_f32 v126, v126
  v_rcp_f32 v128, v128
  v_pk_mul_f32 v[64:65], v[64:65], v[126:127] op_sel_hi:[1,0]
  v_pk_mul_f32 v[4:5], v[4:5], v[128:129] op_sel_hi:[1,0]
  v_pk_mul_f32 v[66:67], v[66:67], v[126:127] op_sel_hi:[1,0]
  v_pk_mul_f32 v[6:7], v[6:7], v[128:129] op_sel_hi:[1,0]
  v_pk_mul_f32 v[68:69], v[68:69], v[126:127] op_sel_hi:[1,0]
  v_pk_mul_f32 v[8:9], v[8:9], v[128:129] op_sel_hi:[1,0]
  v_pk_mul_f32 v[70:71], v[70:71], v[126:127] op_sel_hi:[1,0]
  v_pk_mul_f32 v[10:11], v[10:11], v[128:129] op_sel_hi:[1,0]
  v_pk_mul_f32 v[72:73], v[72:73], v[126:127] op_sel_hi:[1,0]
  v_pk_mul_f32 v[12:13], v[12:13], v[128:129] op_sel_hi:[1,0]
  v_pk_mul_f32 v[74:75], v[74:75], v[126:127] op_sel_hi:[1,0]
  v_pk_mul_f32 v[14:15], v[14:15], v[128:129] op_sel_hi:[1,0]
  v_pk_mul_f32 v[76:77], v[76:77], v[126:127] op_sel_hi:[1,0]
  v_pk_mul_f32 v[16:17], v[16:17], v[128:129] op_sel_hi:[1,0]
  v_pk_mul_f32 v[78:79], v[78:79], v[126:127] op_sel_hi:[1,0]
  v_pk_mul_f32 v[18:19], v[18:19], v[128:129] op_sel_hi:[1,0]
  v_pk_mul_f32 v[80:81], v[80:81], v[126:127] op_sel_hi:[1,0]
  v_pk_mul_f32 v[20:21], v[20:21], v[128:129] op_sel_hi:[1,0]
  v_pk_mul_f32 v[82:83], v[82:83], v[126:127] op_sel_hi:[1,0]
  v_pk_mul_f32 v[22:23], v[22:23], v[128:129] op_sel_hi:[1,0]
  v_cvt_pk_bf16_f32 v36, v64, v65
  v_cvt_pk_bf16_f32 v37, v66, v67
  v_cvt_pk_bf16_f32 v38, v68, v69
  v_cvt_pk_bf16_f32 v39, v70, v71
  v_cvt_pk_bf16_f32 v40, v72, v73
  v_cvt_pk_bf16_f32 v41, v74, v75
  v_cvt_pk_bf16_f32 v42, v76, v77
  v_cvt_pk_bf16_f32 v43, v78, v79
  v_cvt_pk_bf16_f32 v44, v80, v81
  v_cvt_pk_bf16_f32 v45, v82, v83
  v_cvt_pk_bf16_f32 v46, v4, v5
  v_cvt_pk_bf16_f32 v47, v6, v7
  v_cvt_pk_bf16_f32 v48, v8, v9
  v_cvt_pk_bf16_f32 v49, v10, v11
  v_cvt_pk_bf16_f32 v50, v12, v13
  v_cvt_pk_bf16_f32 v51, v14, v15
  v_cvt_pk_bf16_f32 v52, v16, v17
  v_cvt_pk_bf16_f32 v53, v18, v19
  v_cvt_pk_bf16_f32 v54, v20, v21
  v_cvt_pk_bf16_f32 v55, v22, v23
  s_mov_b32 s48, 429496730
  v_mul_hi_u32 v3, v0, s48
  v_mul_u32_u24 v4, 10, v3
  v_sub_u32 v4, v0, v4
  s_lshl_b32 s48, s4, 6
  v_min_u32 v3, 63, v3
  v_add_u32 v5, s48, v3
  v_mul_u32_u24 v6, 1280, v5
  v_lshl_add_u32 v6, v4, 4, v6
  s_mul_i32 s48, s5, 160
  buffer_load_dwordx4 v[8:11], v6, s[56:59], s48 offen
  v_lshlrev_b32 v7, 4, v5
  v_add_u32 v7, 4096, v7
  buffer_load_dwordx4 v[12:15], v7, s[64:67], 0 offen sc1
  v_cmp_le_u32 vcc, 210, v0
  v_mov_b32 v24, 23520
  s_nop 0
  v_cndmask_b32 v24, 0, v24, vcc
  v_lshl_add_u32 v16, v0, 4, v24
  v_subrev_u32 v24, 210, v0
  v_cndmask_b32 v24, v0, v24, vcc
  v_lshlrev_b32 v24, 5, v24
  v_add_u32 v17, 107520, v24
  v_lshlrev_b32 v24, 4, v0
  v_add_u32 v18, 114240, v24
  s_mul_i32 s24, s36, 53760
  s_add_u32 s24, s24, 1048576
  v_bfe_u32 v24, v1, 3, 2
  v_bfe_u32 v25, v1, 2, 1
  v_and_b32 v26, 3, v1
  v_lshrrev_b32 v27, 5, v1
  v_lshl_add_u32 v24, v24, 2, v26
  v_mul_u32_u24 v24, 80, v24
  v_mul_u32_u24 v26, 1680, v25
  v_add_u32 v24, v24, v26
  v_add_u32 v19, 114240, v24
  v_add_u32 v20, 1280, v19
  v_mov_b32 v24, 155648
  v_cmp_eq_u32 vcc, v25, v27
  s_nop 1
  v_cndmask_b32 v19, v24, v19, vcc
  v_cndmask_b32 v20, v24, v20, vcc
  s_lshl_b32 s48, s28, 5
  s_add_u32 s48, s48, s35
  v_and_b32 v24, 31, v1
  v_add_u32 v24, s48, v24
  v_lshrrev_b32 v25, 4, v24
  v_mul_u32_u24 v25, 20480, v25
  v_and_b32 v24, 15, v24
  v_lshl_add_u32 v25, v24, 4, v25
  v_lshrrev_b32 v26, 5, v1
  v_lshl_add_u32 v21, v26, 9, v25
  v_lshl_add_u32 v22, v26, 3, v25
  s_mul_i32 s25, s36, 1280
  s_add_u32 s25, s25, 2097152
  v_cmp_gt_u32 vcc, 420, v0
  s_nop 0
  s_mov_b64 s[72:73], vcc
  v_cmp_gt_u32 vcc, 210, v0
  s_nop 0
  s_mov_b64 s[74:75], vcc
  s_barrier
  s_mov_b64 exec, s[72:73]
  s_cbranch_execz L_nokv_132
  buffer_load_dwordx4 v[56:59], v16, s[64:67], s24 offen sc1
  s_add_u32 s24, s24, 3360
  buffer_load_dwordx4 v[60:63], v16, s[64:67], s24 offen sc1
  s_add_u32 s24, s24, 3360
  buffer_load_dwordx4 v[64:67], v16, s[64:67], s24 offen sc1
  s_add_u32 s24, s24, 3360
  buffer_load_dwordx4 v[68:71], v16, s[64:67], s24 offen sc1
  s_add_u32 s24, s24, 3360
  buffer_load_dwordx4 v[72:75], v16, s[64:67], s24 offen sc1
  s_add_u32 s24, s24, 3360
  buffer_load_dwordx4 v[76:79], v16, s[64:67], s24 offen sc1
  s_add_u32 s24, s24, 3360
  buffer_load_dwordx4 v[80:83], v16, s[64:67], s24 offen sc1
  s_add_u32 s24, s24, 3360
  buffer_load_dwordx4 v[84:87], v16, s[64:67], s24 offen sc1
  s_waitcnt vmcnt(7)
  v_lshlrev_b32 v24, 16, v56
  v_and_b32 v25, s34, v56
  v_lshlrev_b32 v26, 16, v57
  v_and_b32 v27, s34, v57
  v_lshlrev_b32 v28, 16, v58
  v_and_b32 v29, s34, v58
  v_lshlrev_b32 v30, 16, v59
  v_and_b32 v31, s34, v59
  s_waitcnt vmcnt(6)
  v_lshlrev_b32 v32, 16, v60
  v_and_b32 v33, s34, v60
  v_pk_add_f32 v[24:25], v[24:25], v[32:33]
  v_lshlrev_b32 v34, 16, v61
  v_and_b32 v35, s34, v61
  v_pk_add_f32 v[26:27], v[26:27], v[34:35]
  v_lshlrev_b32 v32, 16, v62
  v_and_b32 v33, s34, v62
  v_pk_add_f32 v[28:29], v[28:29], v[32:33]
  v_lshlrev_b32 v34, 16, v63
  v_and_b32 v35, s34, v63
  v_pk_add_f32 v[30:31], v[30:31], v[34:35]
  s_waitcnt vmcnt(5)
  v_lshlrev_b32 v32, 16, v64
  v_and_b32 v33, s34, v64
  v_pk_add_f32 v[24:25], v[24:25], v[32:33]
  v_lshlrev_b32 v34, 16, v65
  v_and_b32 v35, s34, v65
  v_pk_add_f32 v[26:27], v[26:27], v[34:35]
  v_lshlrev_b32 v32, 16, v66
  v_and_b32 v33, s34, v66
  v_pk_add_f32 v[28:29], v[28:29], v[32:33]
  v_lshlrev_b32 v34, 16, v67
  v_and_b32 v35, s34, v67
  v_pk_add_f32 v[30:31], v[30:31], v[34:35]
  s_waitcnt vmcnt(4)
  v_lshlrev_b32 v32, 16, v68
  v_and_b32 v33, s34, v68
  v_pk_add_f32 v[24:25], v[24:25], v[32:33]
  v_lshlrev_b32 v34, 16, v69
  v_and_b32 v35, s34, v69
  v_pk_add_f32 v[26:27], v[26:27], v[34:35]
  v_lshlrev_b32 v32, 16, v70
  v_and_b32 v33, s34, v70
  v_pk_add_f32 v[28:29], v[28:29], v[32:33]
  v_lshlrev_b32 v34, 16, v71
  v_and_b32 v35, s34, v71
  v_pk_add_f32 v[30:31], v[30:31], v[34:35]
  s_waitcnt vmcnt(3)
  v_lshlrev_b32 v32, 16, v72
  v_and_b32 v33, s34, v72
  v_pk_add_f32 v[24:25], v[24:25], v[32:33]
  v_lshlrev_b32 v34, 16, v73
  v_and_b32 v35, s34, v73
  v_pk_add_f32 v[26:27], v[26:27], v[34:35]
  v_lshlrev_b32 v32, 16, v74
  v_and_b32 v33, s34, v74
  v_pk_add_f32 v[28:29], v[28:29], v[32:33]
  v_lshlrev_b32 v34, 16, v75
  v_and_b32 v35, s34, v75
  v_pk_add_f32 v[30:31], v[30:31], v[34:35]
  s_waitcnt vmcnt(2)
  v_lshlrev_b32 v32, 16, v76
  v_and_b32 v33, s34, v76
  v_pk_add_f32 v[24:25], v[24:25], v[32:33]
  v_lshlrev_b32 v34, 16, v77
  v_and_b32 v35, s34, v77
  v_pk_add_f32 v[26:27], v[26:27], v[34:35]
  v_lshlrev_b32 v32, 16, v78
  v_and_b32 v33, s34, v78
  v_pk_add_f32 v[28:29], v[28:29], v[32:33]
  v_lshlrev_b32 v34, 16, v79
  v_and_b32 v35, s34, v79
  v_pk_add_f32 v[30:31], v[30:31], v[34:35]
  s_waitcnt vmcnt(1)
  v_lshlrev_b32 v32, 16, v80
  v_and_b32 v33, s34, v80
  v_pk_add_f32 v[24:25], v[24:25], v[32:33]
  v_lshlrev_b32 v34, 16, v81
  v_and_b32 v35, s34, v81
  v_pk_add_f32 v[26:27], v[26:27], v[34:35]
  v_lshlrev_b32 v32, 16, v82
  v_and_b32 v33, s34, v82
  v_pk_add_f32 v[28:29], v[28:29], v[32:33]
  v_lshlrev_b32 v34, 16, v83
  v_and_b32 v35, s34, v83
  v_pk_add_f32 v[30:31], v[30:31], v[34:35]
  s_waitcnt vmcnt(0)
  v_lshlrev_b32 v32, 16, v84
  v_and_b32 v33, s34, v84
  v_pk_add_f32 v[24:25], v[24:25], v[32:33]
  v_lshlrev_b32 v34, 16, v85
  v_and_b32 v35, s34, v85
  v_pk_add_f32 v[26:27], v[26:27], v[34:35]
  v_lshlrev_b32 v32, 16, v86
  v_and_b32 v33, s34, v86
  v_pk_add_f32 v[28:29], v[28:29], v[32:33]
  v_lshlrev_b32 v34, 16, v87
  v_and_b32 v35, s34, v87
  v_pk_add_f32 v[30:31], v[30:31], v[34:35]
  s_andn2_b64 exec, exec, s[74:75]
  ds_write_b128 v17, v[24:27]
  ds_write_b128 v17, v[28:31] offset:16
  s_waitcnt lgkmcnt(0)
L_nokv_132:
  s_mov_b64 exec, -1
  s_waitcnt vmcnt(0) lgkmcnt(0)
  s_barrier
  s_mov_b64 exec, s[74:75]
  s_cbranch_execz L_nokv2_133
  ds_read_b128 v[56:59], v17
  ds_read_b128 v[60:63], v17 offset:16
  s_waitcnt lgkmcnt(1)
  v_pk_add_f32 v[24:25], v[24:25], v[56:57]
  v_pk_add_f32 v[26:27], v[26:27], v[58:59]
  s_waitcnt lgkmcnt(0)
  v_pk_add_f32 v[28:29], v[28:29], v[60:61]
  v_pk_add_f32 v[30:31], v[30:31], v[62:63]
  v_cvt_pk_bf16_f32 v64, v24, v25
  v_cvt_pk_bf16_f32 v65, v26, v27
  v_cvt_pk_bf16_f32 v66, v28, v29
  v_cvt_pk_bf16_f32 v67, v30, v31
  ds_write_b128 v18, v[64:67]
  s_waitcnt lgkmcnt(0)
L_nokv2_133:
  s_mov_b64 exec, -1
  s_waitcnt vmcnt(0) lgkmcnt(0)
  s_barrier
  ds_read_b128 v[56:59], v19 offset:0
  ds_read_b128 v[76:79], v20 offset:0
  ds_read_b128 v[60:63], v19 offset:16
  ds_read_b128 v[80:83], v20 offset:16
  ds_read_b128 v[64:67], v19 offset:32
  ds_read_b128 v[84:87], v20 offset:32
  ds_read_b128 v[68:71], v19 offset:48
  ds_read_b128 v[88:91], v20 offset:48
  ds_read_b128 v[72:75], v19 offset:64
  ds_read_b128 v[92:95], v20 offset:64
  s_waitcnt lgkmcnt(8)
  v_mfma_f32_32x32x16_bf16 v[112:127], v[76:79], v[36:39], 0
  v_mfma_f32_32x32x16_bf16 v[96:111], v[56:59], v[36:39], 0
  s_waitcnt lgkmcnt(6)
  v_mfma_f32_32x32x16_bf16 v[112:127], v[80:83], v[40:43], v[112:127]
  v_mfma_f32_32x32x16_bf16 v[96:111], v[60:63], v[40:43], v[96:111]
  s_waitcnt lgkmcnt(4)
  v_mfma_f32_32x32x16_bf16 v[112:127], v[84:87], v[44:47], v[112:127]
  v_mfma_f32_32x32x16_bf16 v[96:111], v[64:67], v[44:47], v[96:111]
  s_waitcnt lgkmcnt(2)
  v_mfma_f32_32x32x16_bf16 v[112:127], v[88:91], v[48:51], v[112:127]
  v_mfma_f32_32x32x16_bf16 v[96:111], v[68:71], v[48:51], v[96:111]
  s_waitcnt lgkmcnt(0)
  v_mfma_f32_32x32x16_bf16 v[112:127], v[92:95], v[52:55], v[112:127]
  v_mfma_f32_32x32x16_bf16 v[96:111], v[72:75], v[52:55], v[96:111]
  s_nop 10
  v_add_f32 v6, 0x358637bd, v116
  v_rcp_f32 v6, v6
  s_nop 0
  v_pk_mul_f32 v[112:113], v[112:113], v[6:7] op_sel_hi:[1,0]
  v_pk_mul_f32 v[114:115], v[114:115], v[6:7] op_sel_hi:[1,0]
  v_pk_mul_f32 v[96:97], v[96:97], v[6:7] op_sel_hi:[1,0]
  v_pk_mul_f32 v[98:99], v[98:99], v[6:7] op_sel_hi:[1,0]
  v_pk_mul_f32 v[100:101], v[100:101], v[6:7] op_sel_hi:[1,0]
  v_pk_mul_f32 v[102:103], v[102:103], v[6:7] op_sel_hi:[1,0]
  v_pk_mul_f32 v[104:105], v[104:105], v[6:7] op_sel_hi:[1,0]
  v_pk_mul_f32 v[106:107], v[106:107], v[6:7] op_sel_hi:[1,0]
  v_pk_mul_f32 v[108:109], v[108:109], v[6:7] op_sel_hi:[1,0]
  v_pk_mul_f32 v[110:111], v[110:111], v[6:7] op_sel_hi:[1,0]
  v_cvt_pk_bf16_f32 v64, v112, v113
  v_cvt_pk_bf16_f32 v65, v114, v115
  v_cvt_pk_bf16_f32 v56, v96, v97
  v_cvt_pk_bf16_f32 v57, v98, v99
  v_cvt_pk_bf16_f32 v58, v100, v101
  v_cvt_pk_bf16_f32 v59, v102, v103
  v_cvt_pk_bf16_f32 v60, v104, v105
  v_cvt_pk_bf16_f32 v61, v106, v107
  v_cvt_pk_bf16_f32 v62, v108, v109
  v_cvt_pk_bf16_f32 v63, v110, v111
  buffer_store_dwordx2 v[64:65], v22, s[64:67], s25 offen offset:1024 sc1
  buffer_store_dwordx4 v[56:59], v21, s[64:67], s25 offen sc1
  buffer_store_dwordx4 v[60:63], v21, s[64:67], s25 offen offset:256 sc1
  s_nop 1
  s_and_b32 s48, s28, 3
  s_lshl_b32 s49, s4, 2
  s_add_u32 s48, s48, s49
  s_mul_i32 s48, s48, 20480
  s_lshr_b32 s49, s28, 2
  s_mul_i32 s50, s49, 10240
  s_add_u32 s48, s48, s50
  s_add_u32 s7, s48, 2097152
  v_lshrrev_b32 v16, 4, v1
  v_bfe_u32 v17, v1, 2, 2
  v_and_b32 v18, 3, v1
  v_lshlrev_b32 v20, 10, v16
  v_lshl_add_u32 v20, v17, 7, v20
  v_lshl_add_u32 v20, v18, 3, v20
  v_lshrrev_b32 v19, 1, v17
  v_lshl_add_u32 v20, v19, 5, v20
  v_and_b32 v19, 1, v16
  v_lshl_add_u32 v20, v19, 6, v20
  s_mul_i32 s50, s49, 40960
  s_add_u32 s50, s50, 0
  v_xor_b32 v21, 32, v20
  v_xor_b32 v22, 64, v20
  v_xor_b32 v23, 96, v20
  v_add_u32 v20, s50, v20
  v_add_u32 v21, s50, v21
  v_add_u32 v22, s50, v22
  v_add_u32 v23, s50, v23
  v_lshlrev_b32 v6, 8, v16
  v_lshl_add_u32 v6, v17, 5, v6
  v_lshl_add_u32 v6, v18, 3, v6
  s_mul_i32 s50, s49, 10240
  s_add_u32 s50, s50, 81920
  v_add_u32 v6, s50, v6
  v_lshlrev_b32 v19, 7, v19
  v_xor_b32 v7, 128, v19
  v_add_u32 v7, v7, v6
  v_add_u32 v6, v19, v6
  ds_read_b64_tr_b16 v[24:25], v20 offset:0
  ds_read_b64_tr_b16 v[26:27], v20 offset:512
  ds_read_b64_tr_b16 v[28:29], v21 offset:0
  ds_read_b64_tr_b16 v[30:31], v21 offset:512
  ds_read_b64_tr_b16 v[32:33], v22 offset:0
  ds_read_b64_tr_b16 v[34:35], v22 offset:512
  ds_read_b64_tr_b16 v[36:37], v23 offset:0
  ds_read_b64_tr_b16 v[38:39], v23 offset:512
  ds_read_b64_tr_b16 v[40:41], v6 offset:0
  ds_read_b64_tr_b16 v[42:43], v7 offset:0
  ds_read_b64_tr_b16 v[44:45], v20 offset:4096
  ds_read_b64_tr_b16 v[46:47], v20 offset:4608
  ds_read_b64_tr_b16 v[48:49], v21 offset:4096
  ds_read_b64_tr_b16 v[50:51], v21 offset:4608
  ds_read_b64_tr_b16 v[52:53], v22 offset:4096
  ds_read_b64_tr_b16 v[54:55], v22 offset:4608
  ds_read_b64_tr_b16 v[56:57], v23 offset:4096
  ds_read_b64_tr_b16 v[58:59], v23 offset:4608
  ds_read_b64_tr_b16 v[60:61], v6 offset:1024
  ds_read_b64_tr_b16 v[62:63], v7 offset:1024
  ds_read_b64_tr_b16 v[64:65], v20 offset:8192
  ds_read_b64_tr_b16 v[66:67], v20 offset:8704
  ds_read_b64_tr_b16 v[68:69], v21 offset:8192
  ds_read_b64_tr_b16 v[70:71], v21 offset:8704
  ds_read_b64_tr_b16 v[72:73], v22 offset:8192
  ds_read_b64_tr_b16 v[74:75], v22 offset:8704
  ds_read_b64_tr_b16 v[76:77], v23 offset:8192
  ds_read_b64_tr_b16 v[78:79], v23 offset:8704
  ds_read_b64_tr_b16 v[80:81], v6 offset:2048
  ds_read_b64_tr_b16 v[82:83], v7 offset:2048
  v_lshlrev_b32 v16, 4, v1
  s_waitcnt vmcnt(0) lgkmcnt(0)
  s_barrier
  v_mov_b32 v84, 156736
  ds_read_b32 v84, v84
  s_waitcnt lgkmcnt(0)
  v_readfirstlane_b32 s24, v84
  s_barrier
  buffer_load_dwordx4 v[84:87], v16, s[64:67], s7 offen sc1
  s_add_u32 s7, s7, 1024
  buffer_load_dwordx4 v[88:91], v16, s[64:67], s7 offen sc1
  s_add_u32 s7, s7, 1024
  buffer_load_dwordx4 v[92:95], v16, s[64:67], s7 offen sc1
  s_add_u32 s7, s7, 1024
  buffer_load_dwordx4 v[96:99], v16, s[64:67], s7 offen sc1
  s_add_u32 s7, s7, 1024
  buffer_load_dwordx4 v[100:103], v16, s[64:67], s7 offen sc1
  s_add_u32 s7, s7, 1024
  buffer_load_dwordx4 v[104:107], v16, s[64:67], s7 offen sc1
  s_add_u32 s7, s7, 1024
  buffer_load_dwordx4 v[108:111], v16, s[64:67], s7 offen sc1
  s_add_u32 s7, s7, 1024
  buffer_load_dwordx4 v[112:115], v16, s[64:67], s7 offen sc1
  s_add_u32 s7, s7, 1024
  buffer_load_dwordx4 v[116:119], v16, s[64:67], s7 offen sc1
  s_add_u32 s7, s7, 1024
  buffer_load_dwordx4 v[120:123], v16, s[64:67], s7 offen sc1
  s_waitcnt vmcnt(9)
  v_mfma_f32_16x16x32_bf16 v[124:127], v[24:27], v[84:87], 0
  v_mfma_f32_16x16x32_bf16 v[128:131], v[28:31], v[84:87], 0
  v_mfma_f32_16x16x32_bf16 v[132:135], v[32:35], v[84:87], 0
  v_mfma_f32_16x16x32_bf16 v[136:139], v[36:39], v[84:87], 0
  v_mfma_f32_16x16x32_bf16 v[140:143], v[40:43], v[84:87], 0
  ds_read_b64_tr_b16 v[24:25], v20 offset:12288
  ds_read_b64_tr_b16 v[26:27], v20 offset:12800
  ds_read_b64_tr_b16 v[28:29], v21 offset:12288
  ds_read_b64_tr_b16 v[30:31], v21 offset:12800
  ds_read_b64_tr_b16 v[32:33], v22 offset:12288
  ds_read_b64_tr_b16 v[34:35], v22 offset:12800
  ds_read_b64_tr_b16 v[36:37], v23 offset:12288
  ds_read_b64_tr_b16 v[38:39], v23 offset:12800
  ds_read_b64_tr_b16 v[40:41], v6 offset:3072
  ds_read_b64_tr_b16 v[42:43], v7 offset:3072
  s_waitcnt vmcnt(8)
  v_mfma_f32_16x16x32_bf16 v[124:127], v[44:47], v[88:91], v[124:127]
  v_mfma_f32_16x16x32_bf16 v[128:131], v[48:51], v[88:91], v[128:131]
  v_mfma_f32_16x16x32_bf16 v[132:135], v[52:55], v[88:91], v[132:135]
  v_mfma_f32_16x16x32_bf16 v[136:139], v[56:59], v[88:91], v[136:139]
  v_mfma_f32_16x16x32_bf16 v[140:143], v[60:63], v[88:91], v[140:143]
  ds_read_b64_tr_b16 v[44:45], v20 offset:16384
  ds_read_b64_tr_b16 v[46:47], v20 offset:16896
  ds_read_b64_tr_b16 v[48:49], v21 offset:16384
  ds_read_b64_tr_b16 v[50:51], v21 offset:16896
  ds_read_b64_tr_b16 v[52:53], v22 offset:16384
  ds_read_b64_tr_b16 v[54:55], v22 offset:16896
  ds_read_b64_tr_b16 v[56:57], v23 offset:16384
  ds_read_b64_tr_b16 v[58:59], v23 offset:16896
  ds_read_b64_tr_b16 v[60:61], v6 offset:4096
  ds_read_b64_tr_b16 v[62:63], v7 offset:4096
  s_waitcnt vmcnt(7)
  v_mfma_f32_16x16x32_bf16 v[124:127], v[64:67], v[92:95], v[124:127]
  v_mfma_f32_16x16x32_bf16 v[128:131], v[68:71], v[92:95], v[128:131]
  v_mfma_f32_16x16x32_bf16 v[132:135], v[72:75], v[92:95], v[132:135]
  v_mfma_f32_16x16x32_bf16 v[136:139], v[76:79], v[92:95], v[136:139]
  v_mfma_f32_16x16x32_bf16 v[140:143], v[80:83], v[92:95], v[140:143]
  ds_read_b64_tr_b16 v[64:65], v20 offset:20480
  ds_read_b64_tr_b16 v[66:67], v20 offset:20992
  ds_read_b64_tr_b16 v[68:69], v21 offset:20480
  ds_read_b64_tr_b16 v[70:71], v21 offset:20992
  ds_read_b64_tr_b16 v[72:73], v22 offset:20480
  ds_read_b64_tr_b16 v[74:75], v22 offset:20992
  ds_read_b64_tr_b16 v[76:77], v23 offset:20480
  ds_read_b64_tr_b16 v[78:79], v23 offset:20992
  ds_read_b64_tr_b16 v[80:81], v6 offset:5120
  ds_read_b64_tr_b16 v[82:83], v7 offset:5120
  s_waitcnt vmcnt(6) lgkmcnt(15)
  v_mfma_f32_16x16x32_bf16 v[124:127], v[24:27], v[96:99], v[124:127]
  s_waitcnt lgkmcnt(15)
  v_mfma_f32_16x16x32_bf16 v[128:131], v[28:31], v[96:99], v[128:131]
  s_waitcnt lgkmcnt(15)
  v_mfma_f32_16x16x32_bf16 v[132:135], v[32:35], v[96:99], v[132:135]
  s_waitcnt lgkmcnt(15)
  v_mfma_f32_16x16x32_bf16 v[136:139], v[36:39], v[96:99], v[136:139]
  s_waitcnt lgkmcnt(15)
  v_mfma_f32_16x16x32_bf16 v[140:143], v[40:43], v[96:99], v[140:143]
  ds_read_b64_tr_b16 v[24:25], v20 offset:24576
  ds_read_b64_tr_b16 v[26:27], v20 offset:25088
  ds_read_b64_tr_b16 v[28:29], v21 offset:24576
  ds_read_b64_tr_b16 v[30:31], v21 offset:25088
  ds_read_b64_tr_b16 v[32:33], v22 offset:24576
  ds_read_b64_tr_b16 v[34:35], v22 offset:25088
  ds_read_b64_tr_b16 v[36:37], v23 offset:24576
  ds_read_b64_tr_b16 v[38:39], v23 offset:25088
  ds_read_b64_tr_b16 v[40:41], v6 offset:6144
  ds_read_b64_tr_b16 v[42:43], v7 offset:6144
  s_waitcnt vmcnt(5) lgkmcnt(15)
  v_mfma_f32_16x16x32_bf16 v[124:127], v[44:47], v[100:103], v[124:127]
  s_waitcnt lgkmcnt(15)
  v_mfma_f32_16x16x32_bf16 v[128:131], v[48:51], v[100:103], v[128:131]
  s_waitcnt lgkmcnt(15)
  v_mfma_f32_16x16x32_bf16 v[132:135], v[52:55], v[100:103], v[132:135]
  s_waitcnt lgkmcnt(15)
  v_mfma_f32_16x16x32_bf16 v[136:139], v[56:59], v[100:103], v[136:139]
  s_waitcnt lgkmcnt(15)
  v_mfma_f32_16x16x32_bf16 v[140:143], v[60:63], v[100:103], v[140:143]
  ds_read_b64_tr_b16 v[44:45], v20 offset:28672
  ds_read_b64_tr_b16 v[46:47], v20 offset:29184
  ds_read_b64_tr_b16 v[48:49], v21 offset:28672
  ds_read_b64_tr_b16 v[50:51], v21 offset:29184
  ds_read_b64_tr_b16 v[52:53], v22 offset:28672
  ds_read_b64_tr_b16 v[54:55], v22 offset:29184
  ds_read_b64_tr_b16 v[56:57], v23 offset:28672
  ds_read_b64_tr_b16 v[58:59], v23 offset:29184
  ds_read_b64_tr_b16 v[60:61], v6 offset:7168
  ds_read_b64_tr_b16 v[62:63], v7 offset:7168
  s_waitcnt vmcnt(4) lgkmcnt(15)
  v_mfma_f32_16x16x32_bf16 v[124:127], v[64:67], v[104:107], v[124:127]
  s_waitcnt lgkmcnt(15)
  v_mfma_f32_16x16x32_bf16 v[128:131], v[68:71], v[104:107], v[128:131]
  s_waitcnt lgkmcnt(15)
  v_mfma_f32_16x16x32_bf16 v[132:135], v[72:75], v[104:107], v[132:135]
  s_waitcnt lgkmcnt(15)
  v_mfma_f32_16x16x32_bf16 v[136:139], v[76:79], v[104:107], v[136:139]
  s_waitcnt lgkmcnt(15)
  v_mfma_f32_16x16x32_bf16 v[140:143], v[80:83], v[104:107], v[140:143]
  ds_read_b64_tr_b16 v[64:65], v20 offset:32768
  ds_read_b64_tr_b16 v[66:67], v20 offset:33280
  ds_read_b64_tr_b16 v[68:69], v21 offset:32768
  ds_read_b64_tr_b16 v[70:71], v21 offset:33280
  ds_read_b64_tr_b16 v[72:73], v22 offset:32768
  ds_read_b64_tr_b16 v[74:75], v22 offset:33280
  ds_read_b64_tr_b16 v[76:77], v23 offset:32768
  ds_read_b64_tr_b16 v[78:79], v23 offset:33280
  ds_read_b64_tr_b16 v[80:81], v6 offset:8192
  ds_read_b64_tr_b16 v[82:83], v7 offset:8192
  s_waitcnt vmcnt(3) lgkmcnt(15)
  v_mfma_f32_16x16x32_bf16 v[124:127], v[24:27], v[108:111], v[124:127]
  s_waitcnt lgkmcnt(15)
  v_mfma_f32_16x16x32_bf16 v[128:131], v[28:31], v[108:111], v[128:131]
  s_waitcnt lgkmcnt(15)
  v_mfma_f32_16x16x32_bf16 v[132:135], v[32:35], v[108:111], v[132:135]
  s_waitcnt lgkmcnt(15)
  v_mfma_f32_16x16x32_bf16 v[136:139], v[36:39], v[108:111], v[136:139]
  s_waitcnt lgkmcnt(15)
  v_mfma_f32_16x16x32_bf16 v[140:143], v[40:43], v[108:111], v[140:143]
  ds_read_b64_tr_b16 v[24:25], v20 offset:36864
  ds_read_b64_tr_b16 v[26:27], v20 offset:37376
  ds_read_b64_tr_b16 v[28:29], v21 offset:36864
  ds_read_b64_tr_b16 v[30:31], v21 offset:37376
  ds_read_b64_tr_b16 v[32:33], v22 offset:36864
  ds_read_b64_tr_b16 v[34:35], v22 offset:37376
  ds_read_b64_tr_b16 v[36:37], v23 offset:36864
  ds_read_b64_tr_b16 v[38:39], v23 offset:37376
  ds_read_b64_tr_b16 v[40:41], v6 offset:9216
  ds_read_b64_tr_b16 v[42:43], v7 offset:9216
  s_waitcnt vmcnt(2) lgkmcnt(15)
  v_mfma_f32_16x16x32_bf16 v[124:127], v[44:47], v[112:115], v[124:127]
  s_waitcnt lgkmcnt(15)
  v_mfma_f32_16x16x32_bf16 v[128:131], v[48:51], v[112:115], v[128:131]
  s_waitcnt lgkmcnt(15)
  v_mfma_f32_16x16x32_bf16 v[132:135], v[52:55], v[112:115], v[132:135]
  s_waitcnt lgkmcnt(15)
  v_mfma_f32_16x16x32_bf16 v[136:139], v[56:59], v[112:115], v[136:139]
  s_waitcnt lgkmcnt(15)
  v_mfma_f32_16x16x32_bf16 v[140:143], v[60:63], v[112:115], v[140:143]
  s_waitcnt vmcnt(1) lgkmcnt(15)
  v_mfma_f32_16x16x32_bf16 v[124:127], v[64:67], v[116:119], v[124:127]
  s_waitcnt lgkmcnt(15)
  v_mfma_f32_16x16x32_bf16 v[128:131], v[68:71], v[116:119], v[128:131]
  s_waitcnt lgkmcnt(14)
  v_mfma_f32_16x16x32_bf16 v[132:135], v[72:75], v[116:119], v[132:135]
  s_waitcnt lgkmcnt(12)
  v_mfma_f32_16x16x32_bf16 v[136:139], v[76:79], v[116:119], v[136:139]
  s_waitcnt lgkmcnt(10)
  v_mfma_f32_16x16x32_bf16 v[140:143], v[80:83], v[116:119], v[140:143]
  s_waitcnt vmcnt(0) lgkmcnt(8)
  v_mfma_f32_16x16x32_bf16 v[124:127], v[24:27], v[120:123], v[124:127]
  s_waitcnt lgkmcnt(6)
  v_mfma_f32_16x16x32_bf16 v[128:131], v[28:31], v[120:123], v[128:131]
  s_waitcnt lgkmcnt(4)
  v_mfma_f32_16x16x32_bf16 v[132:135], v[32:35], v[120:123], v[132:135]
  s_waitcnt lgkmcnt(2)
  v_mfma_f32_16x16x32_bf16 v[136:139], v[36:39], v[120:123], v[136:139]
  s_waitcnt lgkmcnt(0)
  v_mfma_f32_16x16x32_bf16 v[140:143], v[40:43], v[120:123], v[140:143]
  s_and_b32 s48, s28, 3
  s_lshl_b32 s48, s48, 4
  v_and_b32 v16, 15, v1
  v_add_u32 v16, s48, v16
  v_mul_u32_u24 v16, 336, v16
  v_lshrrev_b32 v17, 4, v1
  v_lshl_add_u32 v16, v17, 4, v16
  s_lshr_b32 s48, s28, 2
  s_mul_i32 s48, s48, 21504
  s_add_u32 s48, s48, 102400
  v_add_u32 v16, s48, v16
  ds_write_b128 v16, v[124:127] offset:0
  ds_write_b128 v16, v[128:131] offset:64
  ds_write_b128 v16, v[132:135] offset:128
  ds_write_b128 v16, v[136:139] offset:192
  ds_write_b128 v16, v[140:143] offset:256
  s_waitcnt lgkmcnt(0)
  s_barrier
  v_cmp_gt_u32 vcc, 640, v0
  s_nop 0
  s_and_saveexec_b64 s[52:53], vcc
  s_cbranch_execz L_noitem_134
  v_mul_u32_u24 v16, 336, v3
  v_lshl_add_u32 v16, v4, 5, v16
  v_add_u32 v16, 102400, v16
  ds_read_b128 v[20:23], v16
  ds_read_b128 v[24:27], v16 offset:16
  ds_read_b128 v[28:31], v16 offset:21504
  ds_read_b128 v[32:35], v16 offset:21520
  s_waitcnt vmcnt(0) lgkmcnt(0)
  s_mov_b32 s50, 0
L_ist_again_135:
  v_cmp_ne_u32 vcc, s29, v13
  v_cmp_ne_u32 s[48:49], s29, v15
  s_nop 1
  s_or_b64 vcc, vcc, s[48:49]
  s_cbranch_vccz L_ist_ok_136
  s_add_u32 s50, s50, 1
  s_cmp_gt_u32 s50, 40000
  s_cbranch_scc1 L_ist_ok_136
  v_lshlrev_b32 v17, 4, v5
  v_add_u32 v17, 4096, v17
  buffer_load_dwordx4 v[12:15], v17, s[64:67], 0 offen sc1
  s_waitcnt vmcnt(0)
  s_branch L_ist_again_135
L_ist_ok_136:
  v_pk_add_f32 v[20:21], v[20:21], v[28:29]
  v_pk_add_f32 v[22:23], v[22:23], v[30:31]
  v_pk_add_f32 v[24:25], v[24:25], v[32:33]
  v_pk_add_f32 v[26:27], v[26:27], v[34:35]
  v_cmp_eq_u32 vcc, s24, v5
  s_nop 0
  s_and_saveexec_b64 s[48:49], vcc
  s_cbranch_execz L_noy_137
  v_lshlrev_b32 v17, 5, v4
  v_add_u32 v17, 159296, v17
  ds_read_b128 v[28:31], v17 offset:0
  ds_read_b128 v[32:35], v17 offset:16
  s_waitcnt lgkmcnt(1)
  v_add_f32 v20, v20, v28
  v_add_f32 v21, v21, v29
  v_add_f32 v22, v22, v30
  v_add_f32 v23, v23, v31
  s_waitcnt lgkmcnt(0)
  v_add_f32 v24, v24, v32
  v_add_f32 v25, v25, v33
  v_add_f32 v26, v26, v34
  v_add_f32 v27, v27, v35
  ds_read_b128 v[28:31], v17 offset:320
  ds_read_b128 v[32:35], v17 offset:336
  s_waitcnt lgkmcnt(1)
  v_add_f32 v20, v20, v28
  v_add_f32 v21, v21, v29
  v_add_f32 v22, v22, v30
  v_add_f32 v23, v23, v31
  s_waitcnt lgkmcnt(0)
  v_add_f32 v24, v24, v32
  v_add_f32 v25, v25, v33
  v_add_f32 v26, v26, v34
  v_add_f32 v27, v27, v35
  ds_read_b128 v[28:31], v17 offset:640
  ds_read_b128 v[32:35], v17 offset:656
  s_waitcnt lgkmcnt(1)
  v_add_f32 v20, v20, v28
  v_add_f32 v21, v21, v29
  v_add_f32 v22, v22, v30
  v_add_f32 v23, v23, v31
  s_waitcnt lgkmcnt(0)
  v_add_f32 v24, v24, v32
  v_add_f32 v25, v25, v33
  v_add_f32 v26, v26, v34
  v_add_f32 v27, v27, v35
  ds_read_b128 v[28:31], v17 offset:960
  ds_read_b128 v[32:35], v17 offset:976
  s_waitcnt lgkmcnt(1)
  v_add_f32 v20, v20, v28
  v_add_f32 v21, v21, v29
  v_add_f32 v22, v22, v30
  v_add_f32 v23, v23, v31
  s_waitcnt lgkmcnt(0)
  v_add_f32 v24, v24, v32
  v_add_f32 v25, v25, v33
  v_add_f32 v26, v26, v34
  v_add_f32 v27, v27, v35
  ds_read_b128 v[28:31], v17 offset:1280
  ds_read_b128 v[32:35], v17 offset:1296
  s_waitcnt lgkmcnt(1)
  v_add_f32 v20, v20, v28
  v_add_f32 v21, v21, v29
  v_add_f32 v22, v22, v30
  v_add_f32 v23, v23, v31
  s_waitcnt lgkmcnt(0)
  v_add_f32 v24, v24, v32
  v_add_f32 v25, v25, v33
  v_add_f32 v26, v26, v34
  v_add_f32 v27, v27, v35
  ds_read_b128 v[28:31], v17 offset:1600
  ds_read_b128 v[32:35], v17 offset:1616
  s_waitcnt lgkmcnt(1)
  v_add_f32 v20, v20, v28
  v_add_f32 v21, v21, v29
  v_add_f32 v22, v22, v30
  v_add_f32 v23, v23, v31
  s_waitcnt lgkmcnt(0)
  v_add_f32 v24, v24, v32
  v_add_f32 v25, v25, v33
  v_add_f32 v26, v26, v34
  v_add_f32 v27, v27, v35
  ds_read_b128 v[28:31], v17 offset:1920
  ds_read_b128 v[32:35], v17 offset:1936
  s_waitcnt lgkmcnt(1)
  v_add_f32 v20, v20, v28
  v_add_f32 v21, v21, v29
  v_add_f32 v22, v22, v30
  v_add_f32 v23, v23, v31
  s_waitcnt lgkmcnt(0)
  v_add_f32 v24, v24, v32
  v_add_f32 v25, v25, v33
  v_add_f32 v26, v26, v34
  v_add_f32 v27, v27, v35
  ds_read_b128 v[28:31], v17 offset:2240
  ds_read_b128 v[32:35], v17 offset:2256
  s_waitcnt lgkmcnt(1)
  v_add_f32 v20, v20, v28
  v_add_f32 v21, v21, v29
  v_add_f32 v22, v22, v30
  v_add_f32 v23, v23, v31
  s_waitcnt lgkmcnt(0)
  v_add_f32 v24, v24, v32
  v_add_f32 v25, v25, v33
  v_add_f32 v26, v26, v34
  v_add_f32 v27, v27, v35
  ds_read_b128 v[28:31], v17 offset:2560
  ds_read_b128 v[32:35], v17 offset:2576
  s_waitcnt lgkmcnt(1)
  v_add_f32 v20, v20, v28
  v_add_f32 v21, v21, v29
  v_add_f32 v22, v22, v30
  v_add_f32 v23, v23, v31
  s_waitcnt lgkmcnt(0)
  v_add_f32 v24, v24, v32
  v_add_f32 v25, v25, v33
  v_add_f32 v26, v26, v34
  v_add_f32 v27, v27, v35
  ds_read_b128 v[28:31], v17 offset:2880
  ds_read_b128 v[32:35], v17 offset:2896
  s_waitcnt lgkmcnt(1)
  v_add_f32 v20, v20, v28
  v_add_f32 v21, v21, v29
  v_add_f32 v22, v22, v30
  v_add_f32 v23, v23, v31
  s_waitcnt lgkmcnt(0)
  v_add_f32 v24, v24, v32
  v_add_f32 v25, v25, v33
  v_add_f32 v26, v26, v34
  v_add_f32 v27, v27, v35
  ds_read_b128 v[28:31], v17 offset:3200
  ds_read_b128 v[32:35], v17 offset:3216
  s_waitcnt lgkmcnt(1)
  v_add_f32 v20, v20, v28
  v_add_f32 v21, v21, v29
  v_add_f32 v22, v22, v30
  v_add_f32 v23, v23, v31
  s_waitcnt lgkmcnt(0)
  v_add_f32 v24, v24, v32
  v_add_f32 v25, v25, v33
  v_add_f32 v26, v26, v34
  v_add_f32 v27, v27, v35
  ds_read_b128 v[28:31], v17 offset:3520
  ds_read_b128 v[32:35], v17 offset:3536
  s_waitcnt lgkmcnt(1)
  v_add_f32 v20, v20, v28
  v_add_f32 v21, v21, v29
  v_add_f32 v22, v22, v30
  v_add_f32 v23, v23, v31
  s_waitcnt lgkmcnt(0)
  v_add_f32 v24, v24, v32
  v_add_f32 v25, v25, v33
  v_add_f32 v26, v26, v34
  v_add_f32 v27, v27, v35
L_noy_137:
  s_mov_b64 exec, s[48:49]
  s_waitcnt vmcnt(0) lgkmcnt(0)
  v_add_f32 v18, 1.0, v14
  v_mul_f32 v6, v12, v14
  v_lshlrev_b32 v28, 16, v8
  v_and_b32 v29, s34, v8
  v_lshlrev_b32 v30, 16, v9
  v_and_b32 v31, s34, v9
  v_lshlrev_b32 v32, 16, v10
  v_and_b32 v33, s34, v10
  v_lshlrev_b32 v34, 16, v11
  v_and_b32 v35, s34, v11
  v_pk_fma_f32 v[28:29], v[28:29], v[18:19], v[6:7] op_sel_hi:[1,0,0] neg_lo:[0,0,1] neg_hi:[0,0,1]
  v_pk_fma_f32 v[30:31], v[30:31], v[18:19], v[6:7] op_sel_hi:[1,0,0] neg_lo:[0,0,1] neg_hi:[0,0,1]
  v_pk_fma_f32 v[32:33], v[32:33], v[18:19], v[6:7] op_sel_hi:[1,0,0] neg_lo:[0,0,1] neg_hi:[0,0,1]
  v_pk_fma_f32 v[34:35], v[34:35], v[18:19], v[6:7] op_sel_hi:[1,0,0] neg_lo:[0,0,1] neg_hi:[0,0,1]
  v_pk_add_f32 v[20:21], v[20:21], v[28:29]
  v_pk_add_f32 v[22:23], v[22:23], v[30:31]
  v_pk_add_f32 v[24:25], v[24:25], v[32:33]
  v_pk_add_f32 v[26:27], v[26:27], v[34:35]
  v_cvt_pk_bf16_f32 v36, v20, v21
  v_cvt_pk_bf16_f32 v37, v22, v23
  v_cvt_pk_bf16_f32 v38, v24, v25
  v_cvt_pk_bf16_f32 v39, v26, v27
  s_mov_b32 s68, s22
  s_mov_b32 s69, s23
  s_mov_b32 s70, 2621440
  s_mov_b32 s71, 0x20000
  v_mul_u32_u24 v16, 1280, v5
  v_lshl_add_u32 v16, v4, 4, v16
  s_mul_i32 s48, s5, 160
  buffer_store_dwordx4 v[36:39], v16, s[68:71], s48 offen
L_noitem_134:
  s_mov_b64 exec, s[52:53]
  s_waitcnt vmcnt(0) lgkmcnt(0)
  s_branch L_end
L_help_Q:
  s_setprio 3
  s_sub_u32 s6, s28, 8
  v_mov_b32 v12, 0
  v_mov_b32 v13, 0
  s_mov_b32 s40, 0
  s_mov_b32 s13, 0
  s_and_b32 s48, s36, 7
  s_mul_i32 s48, s48, 7
  s_mul_i32 s49, s37, 3
  s_add_u32 s48, s48, s49
  s_mul_hi_u32 s49, s48, 429496730
  s_mul_i32 s49, s49, 10
  s_sub_u32 s39, s48, s49
  s_mov_b32 s25, s39
  v_lshrrev_b32 v14, 3, v1
  v_add_u32 v14, s35, v14
  v_mul_u32_u24 v14, 1280, v14
  v_lshrrev_b32 v15, 4, v1
  v_xor_b32 v15, v15, v1
  v_and_b32 v15, 7, v15
  v_lshl_add_u32 v18, v15, 4, v14
  v_xor_b32 v15, 4, v15
  v_lshl_add_u32 v19, v15, 4, v14
  s_mul_i32 s24, s6, 81920
  s_mul_i32 s43, s39, 245760
  s_add_u32 s43, s43, s13
  s_lshl_b32 s44, s39, 7
  s_add_u32 s44, s44, s24
  s_mul_i32 s7, s6, 8192
  s_add_u32 s7, s7, s40
  s_mul_i32 s12, s6, 1024
  s_add_u32 s12, s12, s40
  s_add_u32 m0, s7, 5120
  s_nop 0
  buffer_load_dwordx4 v18, s[56:59], s44 offen lds
  s_add_u32 s48, s44, 10240
  s_add_u32 m0, s7, 6144
  s_nop 0
  buffer_load_dwordx4 v19, s[56:59], s48 offen lds
  s_add_u32 s48, s44, 20480
  s_add_u32 m0, s7, 7168
  s_nop 0
  buffer_load_dwordx4 v18, s[56:59], s48 offen lds
  s_add_u32 s48, s44, 30720
  s_add_u32 m0, s7, 8192
  s_nop 0
  buffer_load_dwordx4 v19, s[56:59], s48 offen lds
  s_add_u32 s48, s44, 40960
  s_add_u32 m0, s7, 9216
  s_nop 0
  buffer_load_dwordx4 v18, s[56:59], s48 offen lds
  s_add_u32 s48, s44, 51200
  s_add_u32 m0, s7, 10240
  s_nop 0
  buffer_load_dwordx4 v19, s[56:59], s48 offen lds
  s_add_u32 s48, s44, 61440
  s_add_u32 m0, s7, 11264
  s_nop 0
  buffer_load_dwordx4 v18, s[56:59], s48 offen lds
  s_add_u32 s48, s44, 71680
  s_add_u32 m0, s7, 12288
  s_nop 0
  buffer_load_dwordx4 v19, s[56:59], s48 offen lds
  v_lshrrev_b32 v20, 2, v1
  v_mul_u32_u24 v20, 3840, v20
  v_and_b32 v21, 3, v1
  v_lshrrev_b32 v22, 1, v21
  v_add_u32 v22, v21, v22
  v_lshl_add_u32 v14, v22, 4, v20
  v_and_b32 v20, 15, v1
  v_mul_u32_u24 v20, 3840, v20
  v_add_u32 v15, 32, v20
  s_mul_i32 s13, s36, 80
  s_mul_i32 s48, s6, 61440
  s_add_u32 s13, s13, s48
  s_mul_i32 s43, s39, 245760
  s_add_u32 s43, s43, s13
  s_lshl_b32 s44, s39, 7
  s_add_u32 s44, s44, s24
  s_mul_i32 s7, s6, 8192
  s_add_u32 s7, s7, s40
  s_mul_i32 s12, s6, 1024
  s_add_u32 s12, s12, s40
  s_add_u32 m0, s12, 0
  s_nop 0
  buffer_load_dwordx4 v14, s[60:63], s43 offen lds
  s_lshl_b32 s49, s6, 8
  s_add_u32 s49, s49, s40
  s_add_u32 m0, s49, 4096
  s_mov_b64 exec, 0xffff
  buffer_load_dwordx4 v15, s[60:63], s43 offen lds
  s_mov_b64 exec, -1
  s_add_u32 s39, s39, 1
  s_cmp_eq_u32 s39, 10
  s_cselect_b32 s39, 0, s39
  s_add_u32 s40, s40, 37888
  s_cmp_eq_u32 s40, 151552
  s_cselect_b32 s40, 0, s40
  s_mov_b32 s68, s8
  s_mov_b32 s69, s9
  s_mov_b32 s70, 25600
  s_mov_b32 s71, 0x20000
  s_cmp_ge_u32 s6, 2
  s_cbranch_scc1 L_nophi_138
  s_mul_i32 s48, s36, 1600
  s_lshl_b32 s49, s6, 10
  s_add_u32 s48, s48, s49
  v_lshlrev_b32 v24, 4, v1
  s_add_u32 m0, s49, 151552
  s_nop 0
  buffer_load_dwordx4 v24, s[68:71], s48 offen lds
L_nophi_138:
  s_cmp_lg_u32 s6, 3
  s_cbranch_scc1 L_nozero_139
  v_mov_b32 v20, 0
  v_mov_b32 v21, 0
  v_mov_b32 v22, 0
  v_mov_b32 v23, 0
  v_lshlrev_b32 v24, 4, v1
  v_add_u32 v24, 155648, v24
  ds_write_b128 v24, v[20:23]
  v_mov_b32 v24, 163136
  ds_write_b32 v24, v20
  s_waitcnt lgkmcnt(0)
L_nozero_139:
  s_mul_i32 s43, s39, 245760
  s_add_u32 s43, s43, s13
  s_lshl_b32 s44, s39, 7
  s_add_u32 s44, s44, s24
  s_mul_i32 s7, s6, 8192
  s_add_u32 s7, s7, s40
  s_mul_i32 s12, s6, 1024
  s_add_u32 s12, s12, s40
  s_add_u32 m0, s7, 5120
  s_nop 0
  buffer_load_dwordx4 v18, s[56:59], s44 offen lds
  s_add_u32 m0, s12, 0
  s_nop 0
  buffer_load_dwordx4 v14, s[60:63], s43 offen lds
  s_add_u32 s48, s44, 10240
  s_add_u32 m0, s7, 6144
  s_nop 0
  buffer_load_dwordx4 v19, s[56:59], s48 offen lds
  s_add_u32 s48, s44, 20480
  s_add_u32 m0, s7, 7168
  s_nop 0
  buffer_load_dwordx4 v18, s[56:59], s48 offen lds
  s_add_u32 s48, s44, 30720
  s_add_u32 m0, s7, 8192
  s_nop 0
  buffer_load_dwordx4 v19, s[56:59], s48 offen lds
  s_add_u32 s48, s44, 40960
  s_add_u32 m0, s7, 9216
  s_nop 0
  buffer_load_dwordx4 v18, s[56:59], s48 offen lds
  s_lshl_b32 s49, s6, 8
  s_add_u32 s49, s49, s40
  s_add_u32 m0, s49, 4096
  s_mov_b64 exec, 0xffff
  buffer_load_dwordx4 v15, s[60:63], s43 offen lds
  s_mov_b64 exec, -1
  s_add_u32 s48, s44, 51200
  s_add_u32 m0, s7, 10240
  s_nop 0
  buffer_load_dwordx4 v19, s[56:59], s48 offen lds
  s_add_u32 s48, s44, 61440
  s_add_u32 m0, s7, 11264
  s_nop 0
  buffer_load_dwordx4 v18, s[56:59], s48 offen lds
  s_add_u32 s48, s44, 71680
  s_add_u32 m0, s7, 12288
  s_nop 0
  buffer_load_dwordx4 v19, s[56:59], s48 offen lds
  s_add_u32 s39, s39, 1
  s_cmp_eq_u32 s39, 10
  s_cselect_b32 s39, 0, s39
  s_add_u32 s40, s40, 37888
  s_cmp_eq_u32 s40, 151552
  s_cselect_b32 s40, 0, s40
  s_waitcnt lgkmcnt(0)
  s_mul_i32 s29, s30, 0x9E3779B1
  s_add_u32 s29, s29, 0x7F4A7C15
  s_mov_b32 s38, 0
  s_waitcnt lgkmcnt(0)
L_lloop_Q:
  s_cmp_eq_u32 s38, 9
  s_cbranch_scc1 L_hw2_140
  s_waitcnt vmcnt(10)
  s_branch L_hgo_141
L_hw2_140:
  s_waitcnt vmcnt(0)
L_hgo_141:
  s_barrier
  s_cmp_gt_u32 s38, 7
  s_cbranch_scc1 L_lnodma_142
  s_mul_i32 s43, s39, 245760
  s_add_u32 s43, s43, s13
  s_lshl_b32 s44, s39, 7
  s_add_u32 s44, s44, s24
  s_mul_i32 s7, s6, 8192
  s_add_u32 s7, s7, s40
  s_mul_i32 s12, s6, 1024
  s_add_u32 s12, s12, s40
  s_add_u32 m0, s7, 5120
  s_nop 0
  buffer_load_dwordx4 v18, s[56:59], s44 offen lds
  s_add_u32 m0, s12, 0
  s_nop 0
  buffer_load_dwordx4 v14, s[60:63], s43 offen lds
  s_add_u32 s48, s44, 10240
  s_add_u32 m0, s7, 6144
  s_nop 0
  buffer_load_dwordx4 v19, s[56:59], s48 offen lds
  s_add_u32 s48, s44, 20480
  s_add_u32 m0, s7, 7168
  s_nop 0
  buffer_load_dwordx4 v18, s[56:59], s48 offen lds
  s_add_u32 s48, s44, 30720
  s_add_u32 m0, s7, 8192
  s_nop 0
  buffer_load_dwordx4 v19, s[56:59], s48 offen lds
  s_add_u32 s48, s44, 40960
  s_add_u32 m0, s7, 9216
  s_nop 0
  buffer_load_dwordx4 v18, s[56:59], s48 offen lds
  s_lshl_b32 s49, s6, 8
  s_add_u32 s49, s49, s40
  s_add_u32 m0, s49, 4096
  s_mov_b64 exec, 0xffff
  buffer_load_dwordx4 v15, s[60:63], s43 offen lds
  s_mov_b64 exec, -1
  s_add_u32 s48, s44, 51200
  s_add_u32 m0, s7, 10240
  s_nop 0
  buffer_load_dwordx4 v19, s[56:59], s48 offen lds
  s_add_u32 s48, s44, 61440
  s_add_u32 m0, s7, 11264
  s_nop 0
  buffer_load_dwordx4 v18, s[56:59], s48 offen lds
  s_add_u32 s48, s44, 71680
  s_add_u32 m0, s7, 12288
  s_nop 0
  buffer_load_dwordx4 v19, s[56:59], s48 offen lds
  s_add_u32 s39, s39, 1
  s_cmp_eq_u32 s39, 10
  s_cselect_b32 s39, 0, s39
  s_add_u32 s40, s40, 37888
  s_cmp_eq_u32 s40, 151552
  s_cselect_b32 s40, 0, s40
L_lnodma_142:
  s_cmp_lg_u32 s38, 0
  s_cbranch_scc1 L_side_143
  s_cmp_lg_u32 s6, 2
  s_cbranch_scc1 L_side_143
  v_and_b32 v21, 7, v1
  v_lshlrev_b32 v21, 2, v21
  v_add_u32 v21, 156672, v21
  ds_read_b32 v22, v21
  s_waitcnt lgkmcnt(0)
  s_nop 1
  v_max_u32_dpp v22, v22, v22 row_shr:1 row_mask:0xf bank_mask:0xf bound_ctrl:0
  s_nop 1
  v_max_u32_dpp v22, v22, v22 row_shr:2 row_mask:0xf bank_mask:0xf bound_ctrl:0
  s_nop 1
  v_max_u32_dpp v22, v22, v22 row_shr:4 row_mask:0xf bank_mask:0xf bound_ctrl:0
  s_nop 1
  v_readlane_b32 s48, v22, 7
  s_lshl_b32 s49, s2, 3
  s_add_u32 s49, s49, 36864
  v_mov_b32 v22, s48
  v_mov_b32 v23, s29
  v_mov_b32 v21, 0
  s_mov_b64 exec, 1
  buffer_store_dwordx2 v[22:23], v21, s[64:67], s49 offen sc1
  s_mov_b64 exec, -1
L_side_143:
  s_cmp_lg_u32 s38, 9
  s_cbranch_scc1 L_side_144
  s_cmp_lg_u32 s6, 3
  s_cbranch_scc1 L_side_144
  v_lshlrev_b32 v12, 3, v1
  v_add_u32 v12, 36864, v12
  buffer_load_dwordx2 v[4:5], v12, s[64:67], 0 offen offset:0 sc1
  buffer_load_dwordx2 v[6:7], v12, s[64:67], 0 offen offset:512 sc1
  buffer_load_dwordx2 v[8:9], v12, s[64:67], 0 offen offset:1024 sc1
  buffer_load_dwordx2 v[10:11], v12, s[64:67], 0 offen offset:1536 sc1
L_side_144:
  s_add_u32 s38, s38, 1
  s_cmp_lt_u32 s38, 10
  s_cbranch_scc1 L_lloop_Q
  s_barrier
  s_cmp_lg_u32 s6, 3
  s_cbranch_scc1 L_only_145
  s_waitcnt vmcnt(0)
  s_mov_b32 s50, 0
L_sel_again_146:
  v_cmp_ne_u32 vcc, s29, v5
  v_cmp_ne_u32 s[48:49], s29, v7
  s_nop 1
  s_or_b64 vcc, vcc, s[48:49]
  v_cmp_ne_u32 s[48:49], s29, v9
  s_nop 1
  s_or_b64 vcc, vcc, s[48:49]
  v_cmp_ne_u32 s[48:49], s29, v11
  s_nop 1
  s_or_b64 vcc, vcc, s[48:49]
  s_cbranch_vccz L_sel_ok_147
  s_add_u32 s50, s50, 1
  s_cmp_gt_u32 s50, 40000
  s_cbranch_scc1 L_sel_ok_147
  v_lshlrev_b32 v12, 3, v1
  v_add_u32 v12, 36864, v12
  buffer_load_dwordx2 v[4:5], v12, s[64:67], 0 offen offset:0 sc1
  buffer_load_dwordx2 v[6:7], v12, s[64:67], 0 offen offset:512 sc1
  buffer_load_dwordx2 v[8:9], v12, s[64:67], 0 offen offset:1024 sc1
  buffer_load_dwordx2 v[10:11], v12, s[64:67], 0 offen offset:1536 sc1
  s_waitcnt vmcnt(0)
  s_branch L_sel_again_146
L_sel_ok_147:
  v_max_u32 v4, v4, v6
  v_max_u32 v8, v8, v10
  v_max_u32 v4, v4, v8
  s_nop 1
  v_max_u32_dpp v4, v4, v4 row_shr:1 row_mask:0xf bank_mask:0xf bound_ctrl:0
  s_nop 1
  v_max_u32_dpp v4, v4, v4 row_shr:2 row_mask:0xf bank_mask:0xf bound_ctrl:0
  s_nop 1
  v_max_u32_dpp v4, v4, v4 row_shr:4 row_mask:0xf bank_mask:0xf bound_ctrl:0
  s_nop 1
  v_max_u32_dpp v4, v4, v4 row_shr:8 row_mask:0xf bank_mask:0xf bound_ctrl:0
  s_nop 1
  v_max_u32_dpp v4, v4, v4 row_bcast:15 row_mask:0xa bank_mask:0xf
  s_nop 1
  v_max_u32_dpp v4, v4, v4 row_bcast:31 row_mask:0xc bank_mask:0xf
  s_nop 0
  v_readlane_b32 s47, v4, 63
  s_nop 0
  s_and_b32 s46, s47, 2047
  s_sub_u32 s46, 2047, s46
  s_cmp_lg_u32 s2, 0
  s_cbranch_scc1 L_noepoch_148
  s_add_u32 s50, s30, 1
  v_mov_b32 v6, s50
  v_mov_b32 v7, 0
  s_mov_b64 exec, 1
  buffer_store_dword v6, v7, s[64:67], 0 offen sc1
  s_mov_b64 exec, -1
L_noepoch_148:
  v_mov_b32 v8, s46
  v_mov_b32 v9, s47
  v_mov_b32 v12, 156736
  s_mov_b64 exec, 1
  ds_write_b64 v12, v[8:9]
  s_mov_b64 exec, -1
  s_waitcnt lgkmcnt(0)
L_only_145:
  s_mov_b32 s48, 429496730
  v_mul_hi_u32 v14, v0, s48
  v_mul_u32_u24 v15, 10, v14
  v_sub_u32 v15, v0, v15
  s_lshl_b32 s48, s4, 6
  v_min_u32 v14, 63, v14
  v_add_u32 v16, s48, v14
  v_mul_u32_u24 v17, 1280, v16
  v_lshl_add_u32 v17, v15, 4, v17
  s_mul_i32 s48, s5, 160
  buffer_load_dwordx4 v[20:23], v17, s[56:59], s48 offen
  v_lshlrev_b32 v18, 4, v16
  v_add_u32 v18, 4096, v18
  buffer_load_dwordx4 v[24:27], v18, s[64:67], 0 offen sc1
  s_mov_b32 s72, s10
  s_mov_b32 s73, s11
  s_mov_b32 s74, 819200
  s_mov_b32 s75, 0x20000
  v_lshrrev_b32 v28, 3, v1
  v_mul_u32_u24 v29, 1280, v28
  v_bfe_u32 v30, v1, 4, 1
  v_and_b32 v31, 7, v1
  s_mul_i32 s76, s5, 160
  s_mul_i32 s49, s6, 204800
  s_add_u32 s76, s76, s49
  v_lshlrev_b32 v32, 1, v30
  v_or_b32 v32, 0, v32
  v_xor_b32 v32, v32, v31
  v_lshl_add_u32 v34, v32, 4, v29
  v_lshlrev_b32 v32, 1, v30
  v_or_b32 v32, 4, v32
  v_xor_b32 v32, v32, v31
  v_lshl_add_u32 v35, v32, 4, v29
  s_mul_i32 s77, s6, 20480
  s_add_u32 s77, s77, 0
  v_lshrrev_b32 v28, 4, v1
  v_bfe_u32 v29, v1, 1, 3
  v_and_b32 v30, 1, v28
  v_lshlrev_b32 v30, 2, v30
  v_xor_b32 v29, v29, v30
  v_and_b32 v30, 1, v1
  v_lshlrev_b32 v30, 4, v30
  v_add_u32 v30, 128, v30
  s_mul_i32 s78, s6, 5120
  s_add_u32 s78, s78, 81920
  v_add_u32 v31, 0, v28
  s_mov_b32 s52, 858993460
  v_mul_hi_u32 v32, v31, s52
  v_mul_u32_u24 v33, 5, v32
  v_sub_u32 v33, v31, v33
  v_lshrrev_b32 v31, 1, v33
  v_add_u32 v31, v33, v31
  v_cmp_gt_u32 vcc, 4, v33
  s_nop 1
  v_cndmask_b32 v31, 2, v31, vcc
  v_mad_u32_u24 v31, v32, 5, v31
  v_lshl_add_u32 v31, v31, 3, v29
  v_mul_u32_u24 v31, 1280, v31
  v_add_u32 v36, v31, v30
  v_add_u32 v31, 4, v28
  s_mov_b32 s52, 858993460
  v_mul_hi_u32 v32, v31, s52
  v_mul_u32_u24 v33, 5, v32
  v_sub_u32 v33, v31, v33
  v_lshrrev_b32 v31, 1, v33
  v_add_u32 v31, v33, v31
  v_cmp_gt_u32 vcc, 4, v33
  s_nop 1
  v_cndmask_b32 v31, 2, v31, vcc
  v_mad_u32_u24 v31, v32, 5, v31
  v_lshl_add_u32 v31, v31, 3, v29
  v_mul_u32_u24 v31, 1280, v31
  v_add_u32 v37, v31, v30
  v_add_u32 v31, 8, v28
  s_mov_b32 s52, 858993460
  v_mul_hi_u32 v32, v31, s52
  v_mul_u32_u24 v33, 5, v32
  v_sub_u32 v33, v31, v33
  v_lshrrev_b32 v31, 1, v33
  v_add_u32 v31, v33, v31
  v_cmp_gt_u32 vcc, 4, v33
  s_nop 1
  v_cndmask_b32 v31, 2, v31, vcc
  v_mad_u32_u24 v31, v32, 5, v31
  v_lshl_add_u32 v31, v31, 3, v29
  v_mul_u32_u24 v31, 1280, v31
  v_add_u32 v38, v31, v30
  v_add_u32 v31, 12, v28
  s_mov_b32 s52, 858993460
  v_mul_hi_u32 v32, v31, s52
  v_mul_u32_u24 v33, 5, v32
  v_sub_u32 v33, v31, v33
  v_lshrrev_b32 v31, 1, v33
  v_add_u32 v31, v33, v31
  v_cmp_gt_u32 vcc, 4, v33
  s_nop 1
  v_cndmask_b32 v31, 2, v31, vcc
  v_mad_u32_u24 v31, v32, 5, v31
  v_lshl_add_u32 v31, v31, 3, v29
  v_mul_u32_u24 v31, 1280, v31
  v_add_u32 v39, v31, v30
  v_add_u32 v31, 16, v28
  s_mov_b32 s52, 858993460
  v_mul_hi_u32 v32, v31, s52
  v_mul_u32_u24 v33, 5, v32
  v_sub_u32 v33, v31, v33
  v_lshrrev_b32 v31, 1, v33
  v_add_u32 v31, v33, v31
  v_cmp_gt_u32 vcc, 4, v33
  s_nop 1
  v_cndmask_b32 v31, 2, v31, vcc
  v_mad_u32_u24 v31, v32, 5, v31
  v_lshl_add_u32 v31, v31, 3, v29
  v_mul_u32_u24 v31, 1280, v31
  v_add_u32 v40, v31, v30
  s_setprio 0
  s_add_u32 m0, s77, 0
  s_add_u32 s79, s76, 0
  buffer_load_dwordx4 v34, s[72:75], s79 offen lds
  s_add_u32 m0, s77, 1024
  s_add_u32 s79, s76, 10240
  buffer_load_dwordx4 v35, s[72:75], s79 offen lds
  s_add_u32 m0, s77, 2048
  s_add_u32 s79, s76, 30720
  buffer_load_dwordx4 v34, s[72:75], s79 offen lds
  s_add_u32 m0, s77, 3072
  s_add_u32 s79, s76, 40960
  buffer_load_dwordx4 v35, s[72:75], s79 offen lds
  s_add_u32 m0, s77, 4096
  s_add_u32 s79, s76, 20480
  buffer_load_dwordx4 v34, s[72:75], s79 offen lds
  s_add_u32 m0, s77, 5120
  s_add_u32 s79, s76, 51200
  buffer_load_dwordx4 v35, s[72:75], s79 offen lds
  s_add_u32 m0, s77, 6144
  s_add_u32 s79, s76, 61440
  buffer_load_dwordx4 v34, s[72:75], s79 offen lds
  s_add_u32 m0, s77, 7168
  s_add_u32 s79, s76, 81920
  buffer_load_dwordx4 v35, s[72:75], s79 offen lds
  s_add_u32 m0, s77, 8192
  s_add_u32 s79, s76, 92160
  buffer_load_dwordx4 v34, s[72:75], s79 offen lds
  s_add_u32 m0, s77, 9216
  s_add_u32 s79, s76, 71680
  buffer_load_dwordx4 v35, s[72:75], s79 offen lds
  s_add_u32 m0, s77, 10240
  s_add_u32 s79, s76, 102400
  buffer_load_dwordx4 v34, s[72:75], s79 offen lds
  s_add_u32 m0, s77, 11264
  s_add_u32 s79, s76, 112640
  buffer_load_dwordx4 v35, s[72:75], s79 offen lds
  s_add_u32 m0, s77, 12288
  s_add_u32 s79, s76, 133120
  buffer_load_dwordx4 v34, s[72:75], s79 offen lds
  s_add_u32 m0, s77, 13312
  s_add_u32 s79, s76, 143360
  buffer_load_dwordx4 v35, s[72:75], s79 offen lds
  s_add_u32 m0, s77, 14336
  s_add_u32 s79, s76, 122880
  buffer_load_dwordx4 v34, s[72:75], s79 offen lds
  s_add_u32 m0, s77, 15360
  s_add_u32 s79, s76, 153600
  buffer_load_dwordx4 v35, s[72:75], s79 offen lds
  s_add_u32 m0, s77, 16384
  s_add_u32 s79, s76, 163840
  buffer_load_dwordx4 v34, s[72:75], s79 offen lds
  s_add_u32 m0, s77, 17408
  s_add_u32 s79, s76, 184320
  buffer_load_dwordx4 v35, s[72:75], s79 offen lds
  s_add_u32 m0, s77, 18432
  s_add_u32 s79, s76, 194560
  buffer_load_dwordx4 v34, s[72:75], s79 offen lds
  s_add_u32 m0, s77, 19456
  s_add_u32 s79, s76, 174080
  buffer_load_dwordx4 v35, s[72:75], s79 offen lds
  s_add_u32 m0, s78, 0
  s_nop 0
  buffer_load_dwordx4 v36, s[72:75], s76 offen lds
  s_add_u32 m0, s78, 1024
  s_nop 0
  buffer_load_dwordx4 v37, s[72:75], s76 offen lds
  s_add_u32 m0, s78, 2048
  s_nop 0
  buffer_load_dwordx4 v38, s[72:75], s76 offen lds
  s_add_u32 m0, s78, 3072
  s_nop 0
  buffer_load_dwordx4 v39, s[72:75], s76 offen lds
  s_add_u32 m0, s78, 4096
  s_nop 0
  buffer_load_dwordx4 v40, s[72:75], s76 offen lds
  s_waitcnt vmcnt(0) lgkmcnt(0)
  s_lshr_b32 s45, s36, 1
  s_cmp_lg_u32 s6, 0
  s_cbranch_scc1 L_only_149
  s_setprio 3
L_only_149:
  s_cmp_lg_u32 s6, 1
  s_cbranch_scc1 L_only_150
  s_setprio 3
L_only_150:
  s_cmp_lg_u32 s6, 0
  s_cbranch_scc1 L_only_151
  s_lshl_b32 s48, s45, 3
  s_add_u32 s48, s48, s37
  s_lshl_b32 s48, s48, 7
  s_add_u32 s48, s48, 65536
  v_min_u32 v3, 15, v1
  v_lshlrev_b32 v3, 2, v3
  v_add_u32 v3, s48, v3
  s_waitcnt vmcnt(0) lgkmcnt(0)
  s_mov_b32 s50, 0
L_f1_152:
  buffer_load_dword v4, v3, s[64:67], 0 offen sc1
  s_waitcnt vmcnt(0)
  v_cmp_ne_u32 vcc, s29, v4
  s_nop 0
  s_cbranch_vccz L_f1_ok_153
  s_sleep 1
  s_add_u32 s50, s50, 1
  s_cmp_gt_u32 s50, 40000
  s_cbranch_scc0 L_f1_152
L_f1_ok_153:
  s_waitcnt vmcnt(0)
L_only_151:
  s_barrier
  s_barrier
  s_barrier
  s_barrier
  s_cmp_lg_u32 s6, 1
  s_cbranch_scc1 L_only_154
  s_lshl_b32 s48, s37, 10
  s_lshl_b32 s49, s36, 2
  s_add_u32 s48, s48, s49
  s_add_u32 s48, s48, 73728
  v_mov_b32 v3, s29
  v_lshlrev_b32 v4, 7, v1
  s_mov_b64 s[54:55], exec
  s_mov_b64 exec, 0xff
  buffer_store_dword v3, v4, s[64:67], s48 offen sc1
  s_mov_b64 exec, s[54:55]
L_only_154:
  s_lshr_b32 s72, s4, 2
  s_cmp_lg_u32 s6, 0
  s_cbranch_scc1 L_only_155
  s_lshl_b32 s48, s72, 3
  s_add_u32 s48, s48, s5
  s_lshl_b32 s48, s48, 7
  s_add_u32 s48, s48, 73728
  v_min_u32 v3, 15, v1
  v_lshlrev_b32 v3, 2, v3
  v_add_u32 v3, s48, v3
  s_waitcnt vmcnt(0) lgkmcnt(0)
  s_mov_b32 s50, 0
L_f2_156:
  buffer_load_dword v4, v3, s[64:67], 0 offen sc1
  s_waitcnt vmcnt(0)
  v_cmp_ne_u32 vcc, s29, v4
  s_nop 0
  s_cbranch_vccz L_f2_ok_157
  s_sleep 1
  s_add_u32 s50, s50, 1
  s_cmp_gt_u32 s50, 40000
  s_cbranch_scc0 L_f2_156
L_f2_ok_157:
  s_waitcnt vmcnt(0)
L_only_155:
  s_barrier
  v_mov_b32 v3, 156736
  ds_read_b32 v3, v3
  s_waitcnt lgkmcnt(0)
  v_readfirstlane_b32 s73, v3
  s_nop 0
  s_lshr_b32 s48, s73, 6
  s_cmp_lg_u32 s48, s4
  s_cbranch_scc1 L_noowner_158
  v_min_u32 v3, 53, v1
  v_lshlrev_b32 v3, 2, v3
  v_add_u32 v3, 81920, v3
  s_waitcnt vmcnt(0) lgkmcnt(0)
  s_mov_b32 s50, 0
L_f3a_159:
  buffer_load_dword v6, v3, s[64:67], 0 offen sc1
  s_waitcnt vmcnt(0)
  v_cmp_ne_u32 vcc, s29, v6
  s_nop 0
  s_cbranch_vccz L_f3a_ok_160
  s_sleep 1
  s_add_u32 s50, s50, 1
  s_cmp_gt_u32 s50, 40000
  s_cbranch_scc0 L_f3a_159
L_f3a_ok_160:
  s_waitcnt vmcnt(0)
  v_add_u32 v3, 216, v3
  s_waitcnt vmcnt(0) lgkmcnt(0)
  s_mov_b32 s50, 0
L_f3b_161:
  buffer_load_dword v6, v3, s[64:67], 0 offen sc1
  s_waitcnt vmcnt(0)
  v_cmp_ne_u32 vcc, s29, v6
  s_nop 0
  s_cbranch_vccz L_f3b_ok_162
  s_sleep 1
  s_add_u32 s50, s50, 1
  s_cmp_gt_u32 s50, 40000
  s_cbranch_scc0 L_f3b_161
L_f3b_ok_162:
  s_waitcnt vmcnt(0)
  s_lshl_b32 s48, s6, 6
  v_add_u32 v3, s48, v1
  s_mov_b32 s49, 214748365
  v_mul_hi_u32 v4, v3, s49
  v_mul_u32_u24 v5, 20, v4
  v_sub_u32 v5, v3, v5
  v_cmp_gt_u32 vcc, 240, v3
  s_nop 0
  s_and_saveexec_b64 s[52:53], vcc
  s_cbranch_execz L_noys_163
  v_mul_u32_u24 v3, 23040, v4
  v_lshl_add_u32 v3, v5, 4, v3
  s_mul_i32 s48, s5, 320
  s_add_u32 s48, s48, 5242880
  buffer_load_dwordx4 v[28:31], v3, s[64:67], s48 offen sc1
  s_add_u32 s48, s48, 2560
  buffer_load_dwordx4 v[32:35], v3, s[64:67], s48 offen sc1
  s_add_u32 s48, s48, 2560
  buffer_load_dwordx4 v[36:39], v3, s[64:67], s48 offen sc1
  s_add_u32 s48, s48, 2560
  buffer_load_dwordx4 v[40:43], v3, s[64:67], s48 offen sc1
  s_add_u32 s48, s48, 2560
  buffer_load_dwordx4 v[44:47], v3, s[64:67], s48 offen sc1
  s_add_u32 s48, s48, 2560
  buffer_load_dwordx4 v[48:51], v3, s[64:67], s48 offen sc1
  s_add_u32 s48, s48, 2560
  buffer_load_dwordx4 v[52:55], v3, s[64:67], s48 offen sc1
  s_add_u32 s48, s48, 2560
  buffer_load_dwordx4 v[56:59], v3, s[64:67], s48 offen sc1
  s_add_u32 s48, s48, 2560
  buffer_load_dwordx4 v[60:63], v3, s[64:67], s48 offen sc1
  s_waitcnt vmcnt(7)
  v_add_f32 v8, v28, v32
  v_add_f32 v9, v29, v33
  v_add_f32 v10, v30, v34
  v_add_f32 v11, v31, v35
  s_waitcnt vmcnt(6)
  v_add_f32 v8, v8, v36
  v_add_f32 v9, v9, v37
  v_add_f32 v10, v10, v38
  v_add_f32 v11, v11, v39
  s_waitcnt vmcnt(5)
  v_add_f32 v8, v8, v40
  v_add_f32 v9, v9, v41
  v_add_f32 v10, v10, v42
  v_add_f32 v11, v11, v43
  s_waitcnt vmcnt(4)
  v_add_f32 v8, v8, v44
  v_add_f32 v9, v9, v45
  v_add_f32 v10, v10, v46
  v_add_f32 v11, v11, v47
  s_waitcnt vmcnt(3)
  v_add_f32 v8, v8, v48
  v_add_f32 v9, v9, v49
  v_add_f32 v10, v10, v50
  v_add_f32 v11, v11, v51
  s_waitcnt vmcnt(2)
  v_add_f32 v8, v8, v52
  v_add_f32 v9, v9, v53
  v_add_f32 v10, v10, v54
  v_add_f32 v11, v11, v55
  s_waitcnt vmcnt(1)
  v_add_f32 v8, v8, v56
  v_add_f32 v9, v9, v57
  v_add_f32 v10, v10, v58
  v_add_f32 v11, v11, v59
  s_waitcnt vmcnt(0)
  v_add_f32 v8, v8, v60
  v_add_f32 v9, v9, v61
  v_add_f32 v10, v10, v62
  v_add_f32 v11, v11, v63
  v_mul_u32_u24 v3, 320, v4
  v_lshl_add_u32 v3, v5, 4, v3
  v_add_u32 v3, 159296, v3
  ds_write_b128 v3, v[8:11]
  s_waitcnt lgkmcnt(0)
L_noys_163:
  s_mov_b64 exec, s[52:53]
  s_waitcnt vmcnt(0) lgkmcnt(0)
L_noowner_158:
  s_waitcnt vmcnt(0) lgkmcnt(0)
  s_barrier
  v_cmp_gt_u32 vcc, 640, v0
  s_nop 0
  s_and_saveexec_b64 s[52:53], vcc
  s_cbranch_execz L_noitem_164
  v_mul_u32_u24 v4, 336, v14
  v_lshl_add_u32 v4, v15, 5, v4
  v_add_u32 v4, 102400, v4
  ds_read_b128 v[28:31], v4
  ds_read_b128 v[32:35], v4 offset:16
  ds_read_b128 v[36:39], v4 offset:21504
  ds_read_b128 v[40:43], v4 offset:21520
  s_waitcnt vmcnt(0) lgkmcnt(0)
  s_mov_b32 s50, 0
L_ist_again_165:
  v_cmp_ne_u32 vcc, s29, v25
  v_cmp_ne_u32 s[48:49], s29, v27
  s_nop 1
  s_or_b64 vcc, vcc, s[48:49]
  s_cbranch_vccz L_ist_ok_166
  s_add_u32 s50, s50, 1
  s_cmp_gt_u32 s50, 40000
  s_cbranch_scc1 L_ist_ok_166
  v_lshlrev_b32 v5, 4, v16
  v_add_u32 v5, 4096, v5
  buffer_load_dwordx4 v[24:27], v5, s[64:67], 0 offen sc1
  s_waitcnt vmcnt(0)
  s_branch L_ist_again_165
L_ist_ok_166:
  v_pk_add_f32 v[28:29], v[28:29], v[36:37]
  v_pk_add_f32 v[30:31], v[30:31], v[38:39]
  v_pk_add_f32 v[32:33], v[32:33], v[40:41]
  v_pk_add_f32 v[34:35], v[34:35], v[42:43]
  v_cmp_eq_u32 vcc, s73, v16
  s_nop 0
  s_and_saveexec_b64 s[48:49], vcc
  s_cbranch_execz L_noy_167
  v_lshlrev_b32 v5, 5, v15
  v_add_u32 v5, 159296, v5
  ds_read_b128 v[36:39], v5 offset:0
  ds_read_b128 v[40:43], v5 offset:16
  s_waitcnt lgkmcnt(1)
  v_add_f32 v28, v28, v36
  v_add_f32 v29, v29, v37
  v_add_f32 v30, v30, v38
  v_add_f32 v31, v31, v39
  s_waitcnt lgkmcnt(0)
  v_add_f32 v32, v32, v40
  v_add_f32 v33, v33, v41
  v_add_f32 v34, v34, v42
  v_add_f32 v35, v35, v43
  ds_read_b128 v[36:39], v5 offset:320
  ds_read_b128 v[40:43], v5 offset:336
  s_waitcnt lgkmcnt(1)
  v_add_f32 v28, v28, v36
  v_add_f32 v29, v29, v37
  v_add_f32 v30, v30, v38
  v_add_f32 v31, v31, v39
  s_waitcnt lgkmcnt(0)
  v_add_f32 v32, v32, v40
  v_add_f32 v33, v33, v41
  v_add_f32 v34, v34, v42
  v_add_f32 v35, v35, v43
  ds_read_b128 v[36:39], v5 offset:640
  ds_read_b128 v[40:43], v5 offset:656
  s_waitcnt lgkmcnt(1)
  v_add_f32 v28, v28, v36
  v_add_f32 v29, v29, v37
  v_add_f32 v30, v30, v38
  v_add_f32 v31, v31, v39
  s_waitcnt lgkmcnt(0)
  v_add_f32 v32, v32, v40
  v_add_f32 v33, v33, v41
  v_add_f32 v34, v34, v42
  v_add_f32 v35, v35, v43
  ds_read_b128 v[36:39], v5 offset:960
  ds_read_b128 v[40:43], v5 offset:976
  s_waitcnt lgkmcnt(1)
  v_add_f32 v28, v28, v36
  v_add_f32 v29, v29, v37
  v_add_f32 v30, v30, v38
  v_add_f32 v31, v31, v39
  s_waitcnt lgkmcnt(0)
  v_add_f32 v32, v32, v40
  v_add_f32 v33, v33, v41
  v_add_f32 v34, v34, v42
  v_add_f32 v35, v35, v43
  ds_read_b128 v[36:39], v5 offset:1280
  ds_read_b128 v[40:43], v5 offset:1296
  s_waitcnt lgkmcnt(1)
  v_add_f32 v28, v28, v36
  v_add_f32 v29, v29, v37
  v_add_f32 v30, v30, v38
  v_add_f32 v31, v31, v39
  s_waitcnt lgkmcnt(0)
  v_add_f32 v32, v32, v40
  v_add_f32 v33, v33, v41
  v_add_f32 v34, v34, v42
  v_add_f32 v35, v35, v43
  ds_read_b128 v[36:39], v5 offset:1600
  ds_read_b128 v[40:43], v5 offset:1616
  s_waitcnt lgkmcnt(1)
  v_add_f32 v28, v28, v36
  v_add_f32 v29, v29, v37
  v_add_f32 v30, v30, v38
  v_add_f32 v31, v31, v39
  s_waitcnt lgkmcnt(0)
  v_add_f32 v32, v32, v40
  v_add_f32 v33, v33, v41
  v_add_f32 v34, v34, v42
  v_add_f32 v35, v35, v43
  ds_read_b128 v[36:39], v5 offset:1920
  ds_read_b128 v[40:43], v5 offset:1936
  s_waitcnt lgkmcnt(1)
  v_add_f32 v28, v28, v36
  v_add_f32 v29, v29, v37
  v_add_f32 v30, v30, v38
  v_add_f32 v31, v31, v39
  s_waitcnt lgkmcnt(0)
  v_add_f32 v32, v32, v40
  v_add_f32 v33, v33, v41
  v_add_f32 v34, v34, v42
  v_add_f32 v35, v35, v43
  ds_read_b128 v[36:39], v5 offset:2240
  ds_read_b128 v[40:43], v5 offset:2256
  s_waitcnt lgkmcnt(1)
  v_add_f32 v28, v28, v36
  v_add_f32 v29, v29, v37
  v_add_f32 v30, v30, v38
  v_add_f32 v31, v31, v39
  s_waitcnt lgkmcnt(0)
  v_add_f32 v32, v32, v40
  v_add_f32 v33, v33, v41
  v_add_f32 v34, v34, v42
  v_add_f32 v35, v35, v43
  ds_read_b128 v[36:39], v5 offset:2560
  ds_read_b128 v[40:43], v5 offset:2576
  s_waitcnt lgkmcnt(1)
  v_add_f32 v28, v28, v36
  v_add_f32 v29, v29, v37
  v_add_f32 v30, v30, v38
  v_add_f32 v31, v31, v39
  s_waitcnt lgkmcnt(0)
  v_add_f32 v32, v32, v40
  v_add_f32 v33, v33, v41
  v_add_f32 v34, v34, v42
  v_add_f32 v35, v35, v43
  ds_read_b128 v[36:39], v5 offset:2880
  ds_read_b128 v[40:43], v5 offset:2896
  s_waitcnt lgkmcnt(1)
  v_add_f32 v28, v28, v36
  v_add_f32 v29, v29, v37
  v_add_f32 v30, v30, v38
  v_add_f32 v31, v31, v39
  s_waitcnt lgkmcnt(0)
  v_add_f32 v32, v32, v40
  v_add_f32 v33, v33, v41
  v_add_f32 v34, v34, v42
  v_add_f32 v35, v35, v43
  ds_read_b128 v[36:39], v5 offset:3200
  ds_read_b128 v[40:43], v5 offset:3216
  s_waitcnt lgkmcnt(1)
  v_add_f32 v28, v28, v36
  v_add_f32 v29, v29, v37
  v_add_f32 v30, v30, v38
  v_add_f32 v31, v31, v39
  s_waitcnt lgkmcnt(0)
  v_add_f32 v32, v32, v40
  v_add_f32 v33, v33, v41
  v_add_f32 v34, v34, v42
  v_add_f32 v35, v35, v43
  ds_read_b128 v[36:39], v5 offset:3520
  ds_read_b128 v[40:43], v5 offset:3536
  s_waitcnt lgkmcnt(1)
  v_add_f32 v28, v28, v36
  v_add_f32 v29, v29, v37
  v_add_f32 v30, v30, v38
  v_add_f32 v31, v31, v39
  s_waitcnt lgkmcnt(0)
  v_add_f32 v32, v32, v40
  v_add_f32 v33, v33, v41
  v_add_f32 v34, v34, v42
  v_add_f32 v35, v35, v43
L_noy_167:
  s_mov_b64 exec, s[48:49]
  s_waitcnt vmcnt(0) lgkmcnt(0)
  v_add_f32 v6, 1.0, v26
  v_mul_f32 v12, v24, v26
  v_lshlrev_b32 v36, 16, v20
  v_and_b32 v37, s34, v20
  v_lshlrev_b32 v38, 16, v21
  v_and_b32 v39, s34, v21
  v_lshlrev_b32 v40, 16, v22
  v_and_b32 v41, s34, v22
  v_lshlrev_b32 v42, 16, v23
  v_and_b32 v43, s34, v23
  v_pk_fma_f32 v[36:37], v[36:37], v[6:7], v[12:13] op_sel_hi:[1,0,0] neg_lo:[0,0,1] neg_hi:[0,0,1]
  v_pk_fma_f32 v[38:39], v[38:39], v[6:7], v[12:13] op_sel_hi:[1,0,0] neg_lo:[0,0,1] neg_hi:[0,0,1]
  v_pk_fma_f32 v[40:41], v[40:41], v[6:7], v[12:13] op_sel_hi:[1,0,0] neg_lo:[0,0,1] neg_hi:[0,0,1]
  v_pk_fma_f32 v[42:43], v[42:43], v[6:7], v[12:13] op_sel_hi:[1,0,0] neg_lo:[0,0,1] neg_hi:[0,0,1]
  v_pk_add_f32 v[28:29], v[28:29], v[36:37]
  v_pk_add_f32 v[30:31], v[30:31], v[38:39]
  v_pk_add_f32 v[32:33], v[32:33], v[40:41]
  v_pk_add_f32 v[34:35], v[34:35], v[42:43]
  v_cvt_pk_bf16_f32 v8, v28, v29
  v_cvt_pk_bf16_f32 v9, v30, v31
  v_cvt_pk_bf16_f32 v10, v32, v33
  v_cvt_pk_bf16_f32 v11, v34, v35
  s_mov_b32 s68, s22
  s_mov_b32 s69, s23
  s_mov_b32 s70, 2621440
  s_mov_b32 s71, 0x20000
  v_mul_u32_u24 v4, 1280, v16
  v_lshl_add_u32 v4, v15, 4, v4
  s_mul_i32 s48, s5, 160
  buffer_store_dwordx4 v[8:11], v4, s[68:71], s48 offen
L_noitem_164:
  s_mov_b64 exec, s[52:53]
  s_branch L_end
L_end:
  s_endpgm
.section .rodata,"a"
.p2align 6
.amdhsa_kernel parallel_sum__linear_kernel_hedgehog__moe_arch_mod__prompt_kernel
  .amdhsa_next_free_vgpr 168
  .amdhsa_next_free_sgpr 80
  .amdhsa_accum_offset 168
  .amdhsa_group_segment_fixed_size 0
  .amdhsa_kernarg_size 96
  .amdhsa_user_sgpr_count 2
  .amdhsa_user_sgpr_kernarg_segment_ptr 1
  .amdhsa_system_sgpr_workgroup_id_x 1
.end_amdhsa_kernel
```
